```python
import torch

def _softmax(x, axis=-1):
    return torch.softmax(x, dim=axis)

def _gelu(x):
    return torch.nn.functional.gelu(x, approximate='tanh')

def _silu(x):
    return torch.nn.functional.silu(x)

def _sigmoid(x):
    return torch.sigmoid(x)

def _layernorm(x, axis=-1, eps=1e-05):
    m = x.mean(dim=axis, keepdim=True)
    v = x.var(dim=axis, keepdim=True, unbiased=False)
    return (x - m) / torch.sqrt(v + eps)

def _scatter_add(tgt, idx, src, axis=0):
    return tgt.clone().index_add_(axis, idx, src)

def _segment_sum(src, seg, n):
    out = torch.zeros((n,) + src.shape[1:], dtype=src.dtype)
    return out.index_add_(0, seg, src)

def _pad(x, pw):
    flat = tuple((v for pair in reversed(pw) for v in pair))
    return torch.nn.functional.pad(x, flat)
kernel_name = 'standalone__autoregressive_conv_wavenet__speech'

def setup_inputs():

    _w = lambda a: (lambda t: t.to(torch.bfloat16) if t.is_floating_point() else t)(torch.as_tensor(a))
    B, T, D, K = (2, 1000, 512, 3)
    return {'x': _w((lambda *s: torch.randn(*s, dtype=torch.bfloat16) * 0.1)(B, T, D)), 'w': _w((lambda *s: torch.randn(*s, dtype=torch.bfloat16) * 0.1)(K, D, 2 * D)), 'w_o': _w((lambda *s: torch.randn(*s, dtype=torch.bfloat16) * 0.05)(D, D))}

def reference(x, w, w_o):
    B, T, D = x.shape
    K = w.shape[0]
    dil = 2
    pad = (K - 1) * dil
    xp = _pad(x, ((0, 0), (pad, 0), (0, 0)))
    h = torch.einsum('btc,cd->btd', xp[:, pad:pad + T, :], w[0])
    for i in range(1, K):
        off = pad - i * dil
        h = h + torch.einsum('btc,cd->btd', xp[:, off:off + T, :], w[i])
    f = h[..., :D].clone()
    g = h[..., D:].clone()
    z = torch.tanh(f) * _sigmoid(g)
    return z @ w_o
```

```asm
; @launch grid=(256,1,1) block=(512,1,1) lds=126016
.amdgcn_target "amdgcn-amd-amdhsa--gfx950"
.text
.globl standalone__autoregressive_conv_wavenet__speech_kernel
.p2align 12
.fill 0, 4, 0xbf810000
.p2align 8
.type standalone__autoregressive_conv_wavenet__speech_kernel,@function
standalone__autoregressive_conv_wavenet__speech_kernel:
    s_load_dwordx4 s[4:7], s[0:1], 0
    s_load_dwordx4 s[8:11], s[0:1], 16
    s_load_dwordx4 s[12:15], s[0:1], 32
    v_lshrrev_b32 v20, 6, v0
    s_cmp_ge_u32 s2, 256
    s_cbranch_scc1 L_end
    v_readfirstlane_b32 s42, v20
    v_and_b32 v1, 63, v0
    s_bfe_u32 s46, s2, 0x30003
    s_bfe_u32 s72, s2, 0x20001
    s_lshr_b32 s49, s2, 6
    s_and_b32 s3, s2, 1
    s_lshl2_add_u32 s41, s49, s72
    s_xor_b32 s41, s41, 3
    v_lshrrev_b32 v18, 3, v1
    v_and_b32 v19, 7, v1
    s_cmp_lt_u32 s42, 4
    s_cbranch_scc1 L_helper
    s_getpc_b64 s[58:59]
L_pc:
    s_sub_u32 s42, s42, 4
    s_lshr_b32 s44, s2, 3
    s_lshl2_add_u32 s44, s44, s42
    s_lshl_b32 s44, s44, 7
    s_min_u32 s44, s44, 12736
    v_mov_b32 v10, s44
    s_mov_b64 exec, 1
    global_load_dword v11, v10, s[58:59]
    s_mov_b64 exec, -1
    s_branch L_compute
L_helper:
    s_setprio 3
    s_lshl1_add_u32 s44, s3, s72
    s_add_u32 s45, s49, s46
    s_and_b32 s45, s45, 1
    s_lshl1_add_u32 s44, s44, s45
    s_and_b32 s44, s44, 7
    s_lshl_b32 s50, s44, 7
    s_lshl_b32 s52, s44, 17
    v_and_b32 v20, 16, v1
    v_lshlrev_b32 v21, 4, v19
    s_and_b32 s53, s46, 6
    v_lshlrev_b32 v20, 1, v20
    s_lshl_b32 s57, s42, 11
    v_xor_b32 v20, v20, v21
    s_add_u32 s57, s57, 17408
    v_lshl_add_u32 v20, v18, 11, v20
    s_lshr_b32 s45, 36, s53
    s_and_b32 s45, s45, 3
    s_lshl_b32 s73, s45, 20
    s_lshl_b32 s45, s45, 13
    s_add_u32 s29, s57, s45
    s_lshl_b32 s44, s42, 15
    s_lshl_b32 s45, s41, 7
    s_add_u32 s44, s44, s45
    s_lshl_b32 s45, s42, 5
    s_and_b32 s45, s45, 64
    v_xor_b32 v20, s45, v20
    v_add_u32 v28, s44, v20
    s_mov_b32 s22, 3145728
    s_mov_b32 s23, 0x20000
    v_add_u32 v29, 15360, v28
    s_add_u32 m0, s29, 0
    s_add_u32 s60, s52, s73
    s_and_b32 s44, s49, 2
    s_lshl2_add_u32 s62, s42, s44
    s_lshl_b32 s43, s44, 14
    v_lshl_add_u32 v21, v18, 10, v21
    s_sub_u32 s43, 0x4000, s43
    s_mul_i32 s71, s46, 131072
    s_mul_i32 s63, s3, 1024000
    s_mov_b32 s18, 1024000
    s_mov_b32 s19, 0x20000
    v_lshrrev_b32 v16, 5, v1
    s_lshl_b32 s44, s62, 13
    s_add_u32 s44, s44, s71
    v_add_u32 v20, s44, v21
    v_add_u32 v16, s62, v16
    s_lshl_b32 s56, s62, 10
    v_and_b32 v22, 3, v16
    s_add_u32 s56, s56, 1024
    v_lshlrev_b32 v22, 4, v22
    s_mov_b32 s51, s50
    v_xor_b32 v23, v22, v20
    v_add_u32 v22, 1, v16
    v_and_b32 v22, 3, v22
    v_lshlrev_b32 v22, 4, v22
    v_xor_b32 v22, v22, v20
    v_add_u32 v24, 7168, v22
    s_sub_u32 s45, s71, 8192
    v_add_u32 v27, s45, v21
    s_lshl_b32 s44, s42, 3
    s_mov_b32 s54, 0
    s_lshl_b32 s55, 0xff, s44
    v_xad_u32 v25, v23, 32, s43
    s_xor_b32 s28, s62, 2
    s_lshl_b32 s28, s28, 10
    v_xad_u32 v26, v24, 32, s43
    s_add_u32 s28, s28, 1024
    s_waitcnt lgkmcnt(0)
    s_mov_b32 s20, s6
    s_mov_b32 s21, s7
    buffer_load_dwordx4 v28, s[20:23], s60 offen lds
    buffer_load_dwordx4 v29, s[20:23], s60 offen offset:1024 lds
    s_add_u32 m0, s56, 0
    s_add_u32 s16, s4, s63
    s_addc_u32 s17, s5, 0
    buffer_load_dwordx4 v23, s[16:19], s51 offen lds
    buffer_load_dwordx4 v24, s[16:19], s51 offen offset:1024 lds
    s_mov_b32 m0, 0
    s_mov_b64 exec, s[54:55]
    buffer_load_dwordx4 v27, s[16:19], s51 offen lds
    s_mov_b64 exec, -1
    s_add_u32 m0, s28, 0
    s_nop 0
    buffer_load_dwordx4 v25, s[16:19], s51 offen lds
    buffer_load_dwordx4 v26, s[16:19], s51 offen offset:1024 lds
    s_lshr_b32 s45, 73, s53
    s_and_b32 s45, s45, 3
    s_lshl_b32 s74, s45, 20
    s_lshl_b32 s45, s45, 13
    s_add_u32 s30, s57, s45
    s_add_u32 m0, s30, 0
    s_add_u32 s60, s52, s74
    buffer_load_dwordx4 v28, s[20:23], s60 offen lds
    buffer_load_dwordx4 v29, s[20:23], s60 offen offset:1024 lds
    s_lshr_b32 s45, 146, s53
    s_and_b32 s45, s45, 3
    s_lshl_b32 s75, s45, 20
    s_lshl_b32 s45, s45, 13
    s_add_u32 s31, s57, s45
    s_add_u32 m0, s31, 0
    s_add_u32 s60, s52, s75
    buffer_load_dwordx4 v28, s[20:23], s60 offen lds
    buffer_load_dwordx4 v29, s[20:23], s60 offen offset:1024 lds
    s_setprio 0
    s_lshl_b32 s63, s42, 2
    s_add_u32 s63, s63, 125952
    v_mov_b32 v20, s63
    v_mov_b32 v3, -1
    v_mov_b32 v22, 0x7ffffff0
    ds_write_b32 v20, v3
    ds_write_b32 v20, v3 offset:16
    s_lshl3_add_u32 s40, s3, s46
    v_mov_b32 v2, 0
    v_and_b32 v17, 15, v1
    v_lshrrev_b32 v16, 4, v1
    s_mov_b32 s36, s14
    s_mov_b32 s37, s15
    s_mov_b32 s38, 0x10000000
    s_mov_b32 s39, 0x20000
    s_lshl_b32 s32, s40, 7
    s_add_u32 s32, s32, 4194304
    s_load_dword s5, s[36:37], s32
    s_and_b32 s66, s46, 3
    s_xor_b32 s66, s66, s42
    s_mov_b32 s24, s8
    s_mov_b32 s25, s9
    s_mov_b32 s26, 524288
    s_mov_b32 s27, 0x20000
    s_lshr_b32 s65, s46, 2
    s_mul_i32 s65, s65, 3
    s_lshl_b32 s44, s65, 15
    s_xor_b32 s8, s44, 0
    s_xor_b32 s9, s44, 16384
    s_xor_b32 s10, s44, 32768
    s_xor_b32 s11, s44, 49152
    s_xor_b32 s12, s44, 65536
    s_xor_b32 s13, s44, 81920
    s_xor_b32 s14, s44, 98304
    s_xor_b32 s15, s44, 114688
    s_mov_b32 s47, 0x05040100
    s_mov_b32 s48, 0x07060302
    s_lshl_b32 s44, s65, 13
    s_and_b32 s32, s44, 16384
    s_xor_b32 s33, s32, 16384
    s_xor_b32 s34, s32, 131072
    s_xor_b32 s35, s32, 147456
    s_xor_b32 s67, s32, 8192
    s_xor_b32 s68, s32, 24576
    s_xor_b32 s69, s32, 139264
    s_xor_b32 s70, s32, 155648
    v_lshlrev_b32 v20, 12, v16
    v_lshl_add_u32 v20, v17, 4, v20
    s_lshl_b32 s44, s66, 17
    s_lshl_b32 s45, s49, 8
    s_add_u32 s44, s44, s45
    v_add_u32 v15, s44, v20
    s_mul_i32 s44, s66, 8192
    v_lshl_add_u32 v8, v1, 4, s44
    s_lshr_b32 s62, s72, 1
    s_and_b32 s71, s72, 1
    v_lshrrev_b32 v20, 3, v17
    v_lshlrev_b32 v20, 12, v20
    v_lshl_add_u32 v20, v16, 8, v20
    v_lshl_add_u32 v20, v19, 4, v20
    s_lshl_b32 s44, s40, 18
    s_lshl_b32 s45, s66, 15
    s_add_u32 s44, s44, s45
    s_lshl_b32 s45, s62, 11
    s_add_u32 s44, s44, s45
    s_lshl_b32 s45, s71, 7
    s_add_u32 s44, s44, s45
    s_lshl_b32 s45, s65, 10
    s_and_b32 s45, s45, 1024
    s_add_u32 s44, s44, s45
    v_add_u32 v5, s44, v20
    v_xor_b32 v14, 1024, v5
    v_lshl_add_u32 v6, v19, 2, 4
    v_mul_u32_u24 v11, 11, v19
    s_mov_b32 s64, 458759
    s_xor_b32 s51, s51, 128
    s_xor_b32 s52, s52, 0x20000
    s_add_u32 m0, s29, 41984
    s_add_u32 s60, s52, s73
    buffer_load_dwordx4 v28, s[20:23], s60 offen lds
    buffer_load_dwordx4 v29, s[20:23], s60 offen offset:1024 lds
    s_add_u32 m0, s56, 41984
    s_nop 0
    buffer_load_dwordx4 v23, s[16:19], s51 offen lds
    buffer_load_dwordx4 v24, s[16:19], s51 offen offset:1024 lds
    s_mov_b32 m0, 41984
    s_mov_b64 exec, s[54:55]
    buffer_load_dwordx4 v27, s[16:19], s51 offen lds
    s_mov_b64 exec, -1
    s_add_u32 m0, s28, 41984
    s_nop 0
    buffer_load_dwordx4 v25, s[16:19], s51 offen lds
    buffer_load_dwordx4 v26, s[16:19], s51 offen offset:1024 lds
    s_add_u32 m0, s30, 41984
    s_add_u32 s60, s52, s74
    buffer_load_dwordx4 v28, s[20:23], s60 offen lds
    buffer_load_dwordx4 v29, s[20:23], s60 offen offset:1024 lds
    s_setprio 1
    s_waitcnt vmcnt(9)
    s_barrier
    s_add_u32 m0, s31, 41984
    s_add_u32 s60, s52, s75
    buffer_load_dwordx4 v28, s[20:23], s60 offen lds
    buffer_load_dwordx4 v29, s[20:23], s60 offen offset:1024 lds
    s_setprio 0
    s_add_u32 s51, s50, 512
    s_and_b32 s51, s51, 0x380
    s_lshl_b32 s52, s51, 10
    s_add_u32 m0, s29, 83968
    s_add_u32 s60, s52, s73
    buffer_load_dwordx4 v28, s[20:23], s60 offen lds
    buffer_load_dwordx4 v29, s[20:23], s60 offen offset:1024 lds
    s_add_u32 m0, s56, 83968
    s_nop 0
    buffer_load_dwordx4 v23, s[16:19], s51 offen lds
    buffer_load_dwordx4 v24, s[16:19], s51 offen offset:1024 lds
    s_mov_b32 m0, 83968
    s_mov_b64 exec, s[54:55]
    buffer_load_dwordx4 v27, s[16:19], s51 offen lds
    s_mov_b64 exec, -1
    s_add_u32 m0, s28, 83968
    s_nop 0
    buffer_load_dwordx4 v25, s[16:19], s51 offen lds
    buffer_load_dwordx4 v26, s[16:19], s51 offen offset:1024 lds
    s_add_u32 m0, s30, 83968
    s_add_u32 s60, s52, s74
    buffer_load_dwordx4 v28, s[20:23], s60 offen lds
    buffer_load_dwordx4 v29, s[20:23], s60 offen offset:1024 lds
    s_add_u32 m0, s31, 83968
    s_add_u32 s60, s52, s75
    buffer_load_dwordx4 v28, s[20:23], s60 offen lds
    buffer_load_dwordx4 v29, s[20:23], s60 offen offset:1024 lds
    s_waitcnt vmcnt(11)
    s_barrier
    s_xor_b32 s51, s51, 128
    s_xor_b32 s52, s52, 0x20000
    s_add_u32 m0, s29, 0
    s_add_u32 s60, s52, s73
    buffer_load_dwordx4 v28, s[20:23], s60 offen lds
    buffer_load_dwordx4 v29, s[20:23], s60 offen offset:1024 lds
    s_add_u32 m0, s56, 0
    s_nop 0
    buffer_load_dwordx4 v23, s[16:19], s51 offen lds
    buffer_load_dwordx4 v24, s[16:19], s51 offen offset:1024 lds
    s_mov_b32 m0, 0
    s_mov_b64 exec, s[54:55]
    buffer_load_dwordx4 v27, s[16:19], s51 offen lds
    s_mov_b64 exec, -1
    s_add_u32 m0, s28, 0
    s_nop 0
    buffer_load_dwordx4 v25, s[16:19], s51 offen lds
    buffer_load_dwordx4 v26, s[16:19], s51 offen offset:1024 lds
    s_add_u32 m0, s30, 0
    s_add_u32 s60, s52, s74
    buffer_load_dwordx4 v28, s[20:23], s60 offen lds
    buffer_load_dwordx4 v29, s[20:23], s60 offen offset:1024 lds
    s_add_u32 m0, s31, 0
    s_add_u32 s60, s52, s75
    buffer_load_dwordx4 v28, s[20:23], s60 offen lds
    buffer_load_dwordx4 v29, s[20:23], s60 offen offset:1024 lds
    s_waitcnt vmcnt(11)
    s_barrier
    s_add_u32 s51, s50, 256
    s_and_b32 s51, s51, 0x380
    s_lshl_b32 s52, s51, 10
    s_add_u32 m0, s29, 41984
    s_add_u32 s60, s52, s73
    buffer_load_dwordx4 v28, s[20:23], s60 offen lds
    buffer_load_dwordx4 v29, s[20:23], s60 offen offset:1024 lds
    s_add_u32 m0, s56, 41984
    s_nop 0
    buffer_load_dwordx4 v23, s[16:19], s51 offen lds
    buffer_load_dwordx4 v24, s[16:19], s51 offen offset:1024 lds
    s_mov_b32 m0, 41984
    s_mov_b64 exec, s[54:55]
    buffer_load_dwordx4 v27, s[16:19], s51 offen lds
    s_mov_b64 exec, -1
    s_add_u32 m0, s28, 41984
    s_nop 0
    buffer_load_dwordx4 v25, s[16:19], s51 offen lds
    buffer_load_dwordx4 v26, s[16:19], s51 offen offset:1024 lds
    s_add_u32 m0, s30, 41984
    s_add_u32 s60, s52, s74
    buffer_load_dwordx4 v28, s[20:23], s60 offen lds
    buffer_load_dwordx4 v29, s[20:23], s60 offen offset:1024 lds
    s_add_u32 m0, s31, 41984
    s_add_u32 s60, s52, s75
    buffer_load_dwordx4 v28, s[20:23], s60 offen lds
    buffer_load_dwordx4 v29, s[20:23], s60 offen offset:1024 lds
    s_waitcnt lgkmcnt(0)
    s_waitcnt vmcnt(11)
    s_barrier
    s_xor_b32 s51, s51, 128
    s_xor_b32 s52, s52, 0x20000
    s_add_u32 m0, s29, 83968
    s_add_u32 s60, s52, s73
    buffer_load_dwordx4 v28, s[20:23], s60 offen lds
    buffer_load_dwordx4 v29, s[20:23], s60 offen offset:1024 lds
    s_add_u32 m0, s56, 83968
    s_nop 0
    buffer_load_dwordx4 v23, s[16:19], s51 offen lds
    buffer_load_dwordx4 v24, s[16:19], s51 offen offset:1024 lds
    s_mov_b32 m0, 83968
    s_mov_b64 exec, s[54:55]
    buffer_load_dwordx4 v27, s[16:19], s51 offen lds
    s_mov_b64 exec, -1
    s_add_u32 m0, s28, 83968
    s_nop 0
    buffer_load_dwordx4 v25, s[16:19], s51 offen lds
    buffer_load_dwordx4 v26, s[16:19], s51 offen offset:1024 lds
    s_add_u32 m0, s30, 83968
    s_add_u32 s60, s52, s74
    buffer_load_dwordx4 v28, s[20:23], s60 offen lds
    buffer_load_dwordx4 v29, s[20:23], s60 offen offset:1024 lds
    s_add_u32 m0, s31, 83968
    s_add_u32 s60, s52, s75
    buffer_load_dwordx4 v28, s[20:23], s60 offen lds
    buffer_load_dwordx4 v29, s[20:23], s60 offen offset:1024 lds
    s_waitcnt vmcnt(11)
    s_barrier
    s_add_u32 s51, s50, 768
    s_and_b32 s51, s51, 0x380
    s_lshl_b32 s52, s51, 10
    s_add_u32 m0, s29, 0
    s_add_u32 s60, s52, s73
    buffer_load_dwordx4 v28, s[20:23], s60 offen lds
    buffer_load_dwordx4 v29, s[20:23], s60 offen offset:1024 lds
    s_add_u32 m0, s56, 0
    s_nop 0
    buffer_load_dwordx4 v23, s[16:19], s51 offen lds
    buffer_load_dwordx4 v24, s[16:19], s51 offen offset:1024 lds
    s_mov_b32 m0, 0
    s_mov_b64 exec, s[54:55]
    buffer_load_dwordx4 v27, s[16:19], s51 offen lds
    s_mov_b64 exec, -1
    s_add_u32 m0, s28, 0
    s_nop 0
    buffer_load_dwordx4 v25, s[16:19], s51 offen lds
    buffer_load_dwordx4 v26, s[16:19], s51 offen offset:1024 lds
    s_add_u32 m0, s30, 0
    s_add_u32 s60, s52, s74
    buffer_load_dwordx4 v28, s[20:23], s60 offen lds
    buffer_load_dwordx4 v29, s[20:23], s60 offen offset:1024 lds
    s_add_u32 m0, s31, 0
    s_add_u32 s60, s52, s75
    buffer_load_dwordx4 v28, s[20:23], s60 offen lds
    buffer_load_dwordx4 v29, s[20:23], s60 offen offset:1024 lds
    s_add_u32 m0, s63, 0
    s_mov_b64 exec, 1
    buffer_load_dword v22, s[16:19], 0 offen lds
    s_mov_b64 exec, -1
    s_setprio 1
    s_waitcnt vmcnt(12)
    s_barrier
    s_xor_b32 s51, s51, 128
    s_xor_b32 s52, s52, 0x20000
    s_add_u32 m0, s29, 41984
    s_add_u32 s60, s52, s73
    buffer_load_dwordx4 v28, s[20:23], s60 offen lds
    buffer_load_dwordx4 v29, s[20:23], s60 offen offset:1024 lds
    s_add_u32 m0, s56, 41984
    s_nop 0
    buffer_load_dwordx4 v23, s[16:19], s51 offen lds
    buffer_load_dwordx4 v24, s[16:19], s51 offen offset:1024 lds
    s_mov_b32 m0, 41984
    s_mov_b64 exec, s[54:55]
    buffer_load_dwordx4 v27, s[16:19], s51 offen lds
    s_mov_b64 exec, -1
    s_add_u32 m0, s28, 41984
    s_nop 0
    buffer_load_dwordx4 v25, s[16:19], s51 offen lds
    buffer_load_dwordx4 v26, s[16:19], s51 offen offset:1024 lds
    s_add_u32 m0, s30, 41984
    s_add_u32 s60, s52, s74
    buffer_load_dwordx4 v28, s[20:23], s60 offen lds
    buffer_load_dwordx4 v29, s[20:23], s60 offen offset:1024 lds
    s_add_u32 m0, s31, 41984
    s_add_u32 s60, s52, s75
    buffer_load_dwordx4 v28, s[20:23], s60 offen lds
    buffer_load_dwordx4 v29, s[20:23], s60 offen offset:1024 lds
    s_add_u32 m0, s63, 16
    s_mov_b64 exec, 1
    buffer_load_dword v22, s[16:19], 0 offen lds
    s_mov_b64 exec, -1
    s_setprio 0
    buffer_load_dwordx4 v[32:35], v15, s[24:27], s8 offen
    buffer_load_dwordx4 v[36:39], v15, s[24:27], s8 offen offset:1024
    buffer_load_dwordx4 v[40:43], v15, s[24:27], s8 offen offset:2048
    buffer_load_dwordx4 v[44:47], v15, s[24:27], s8 offen offset:3072
    buffer_load_dwordx4 v[48:51], v15, s[24:27], s9 offen
    buffer_load_dwordx4 v[52:55], v15, s[24:27], s9 offen offset:1024
    buffer_load_dwordx4 v[56:59], v15, s[24:27], s9 offen offset:2048
    buffer_load_dwordx4 v[60:63], v15, s[24:27], s9 offen offset:3072
    buffer_load_dwordx4 v[64:67], v15, s[24:27], s10 offen
    buffer_load_dwordx4 v[68:71], v15, s[24:27], s10 offen offset:1024
    buffer_load_dwordx4 v[72:75], v15, s[24:27], s10 offen offset:2048
    buffer_load_dwordx4 v[76:79], v15, s[24:27], s10 offen offset:3072
    buffer_load_dwordx4 v[80:83], v15, s[24:27], s11 offen
    buffer_load_dwordx4 v[84:87], v15, s[24:27], s11 offen offset:1024
    buffer_load_dwordx4 v[88:91], v15, s[24:27], s11 offen offset:2048
    buffer_load_dwordx4 v[92:95], v15, s[24:27], s11 offen offset:3072
    buffer_load_dwordx4 v[96:99], v15, s[24:27], s12 offen
    buffer_load_dwordx4 v[100:103], v15, s[24:27], s12 offen offset:1024
    buffer_load_dwordx4 v[104:107], v15, s[24:27], s12 offen offset:2048
    buffer_load_dwordx4 v[108:111], v15, s[24:27], s12 offen offset:3072
    buffer_load_dwordx4 v[112:115], v15, s[24:27], s13 offen
    buffer_load_dwordx4 v[116:119], v15, s[24:27], s13 offen offset:1024
    buffer_load_dwordx4 v[120:123], v15, s[24:27], s13 offen offset:2048
    buffer_load_dwordx4 v[124:127], v15, s[24:27], s13 offen offset:3072
    s_add_u32 s5, s5, 1
    v_lshrrev_b32 v3, v6, s5
    v_add3_u32 v3, v3, s5, v11
    v_and_b32 v3, 63, v3
    v_lshl_or_b32 v3, v3, 13, v3
    v_and_b32 v3, s64, v3
    s_mov_b32 s71, 0
    s_branch L_hp
L_compute:
    s_lshl3_add_u32 s40, s3, s46
    s_mul_i32 s43, s46, 131072
    s_mul_i32 s3, s3, 1024000
    v_lshrrev_b32 v16, 4, v1
    v_mov_b32 v2, 0
    v_and_b32 v17, 15, v1
    s_lshr_b32 s44, s42, 1
    s_lshl_b32 s44, s44, 13
    s_add_u32 s44, s44, 512
    v_lshrrev_b32 v20, 1, v17
    v_and_b32 v22, 1, v17
    v_lshl_add_u32 v22, v20, 3, v22
    v_lshlrev_b32 v22, 7, v22
    v_add_u32 v22, s44, v22
    v_and_b32 v10, 1, v16
    v_and_b32 v21, 2, v16
    v_lshl_add_u32 v10, v10, 2, v21
    v_and_b32 v20, 3, v20
    v_xor_b32 v21, v20, v10
    v_lshl_add_u32 v3, v21, 4, v22
    v_xor_b32 v4, 16, v3
    v_add_u32 v20, 1, v20
    v_and_b32 v20, 3, v20
    v_xor_b32 v21, v20, v10
    v_lshl_add_u32 v5, v21, 4, v22
    v_xor_b32 v6, 16, v5
    v_bfe_u32 v20, v1, 2, 2
    v_lshl_add_u32 v21, v10, 3, v20
    v_lshlrev_b32 v21, 7, v21
    v_lshrrev_b32 v20, 1, v20
    v_and_b32 v22, 1, v16
    v_lshl_add_u32 v20, v22, 1, v20
    s_and_b32 s44, s42, 1
    s_lshl_b32 s44, s44, 1
    v_xor_b32 v20, s44, v20
    v_lshl_add_u32 v21, v20, 5, v21
    v_and_b32 v22, 3, v1
    v_lshl_add_u32 v21, v22, 3, v21
    v_add_u32 v7, 17408, v21
    v_xor_b32 v8, 32, v7
    v_lshlrev_b32 v20, 4, v1
    s_lshl_b32 s44, s40, 18
    s_lshl_b32 s45, s42, 10
    s_add_u32 s44, s44, s45
    s_lshl_b32 s45, s41, 14
    s_add_u32 s44, s44, s45
    v_add_u32 v9, s44, v20
    v_lshl_add_u32 v23, v19, 2, 4
    v_mul_u32_u24 v25, 11, v19
    s_mov_b32 s64, 458759
    s_lshr_b32 s62, s42, 1
    s_and_b32 s71, s42, 1
    v_lshlrev_b32 v20, 4, v17
    v_lshl_add_u32 v21, v16, 11, v20
    s_lshl_b32 s44, s42, 8
    v_add_u32 v28, s44, v21
    v_and_b32 v21, 1, v16
    v_lshl_add_u32 v20, v21, 10, v20
    v_lshrrev_b32 v21, 1, v16
    v_lshl_add_u32 v20, v21, 13, v20
    s_lshl_b32 s44, s43, 0
    s_lshl_b32 s45, s72, 15
    s_add_u32 s44, s44, s45
    s_lshl_b32 s45, s49, 8
    s_add_u32 s44, s44, s45
    s_lshl_b32 s45, s62, 11
    s_add_u32 s44, s44, s45
    s_lshl_b32 s45, s71, 14
    s_add_u32 s44, s44, s45
    v_add_u32 v29, s44, v20
    v_mov_b32 v32, 0
    v_mov_b32 v33, 0
    v_mov_b32 v34, 0
    v_mov_b32 v35, 0
    v_mov_b32 v36, 0
    v_mov_b32 v37, 0
    v_mov_b32 v38, 0
    v_mov_b32 v39, 0
    v_mov_b32 v40, 0
    v_mov_b32 v41, 0
    v_mov_b32 v42, 0
    v_mov_b32 v43, 0
    v_mov_b32 v44, 0
    v_mov_b32 v45, 0
    v_mov_b32 v46, 0
    v_mov_b32 v47, 0
    v_mov_b32 v48, 0
    v_mov_b32 v49, 0
    v_mov_b32 v50, 0
    v_mov_b32 v51, 0
    v_mov_b32 v52, 0
    v_mov_b32 v53, 0
    v_mov_b32 v54, 0
    v_mov_b32 v55, 0
    v_mov_b32 v56, 0
    v_mov_b32 v57, 0
    v_mov_b32 v58, 0
    v_mov_b32 v59, 0
    v_mov_b32 v60, 0
    v_mov_b32 v61, 0
    v_mov_b32 v62, 0
    v_mov_b32 v63, 0
    s_mov_b32 s33, 4096
    s_mov_b32 s34, 8192
    s_mov_b32 s35, 12288
    s_mov_b32 s65, 8192
    s_mov_b32 s56, 41984
    s_mov_b32 s71, 0
    s_mov_b32 s61, 0
    s_mov_b32 s62, 0
    v_and_b32 v20, 3, v1
    v_lshlrev_b32 v20, 2, v20
    v_add_u32 v15, 125952, v20
    s_lshl_b32 s32, s40, 7
    s_add_u32 s32, s32, 4194304
    s_waitcnt lgkmcnt(0)
    s_mov_b32 s36, s14
    s_mov_b32 s37, s15
    s_mov_b32 s38, 0x10000000
    s_mov_b32 s39, 0x20000
    s_load_dword s7, s[36:37], s32
    s_add_u32 s28, s10, s3
    s_addc_u32 s29, s11, 0
    s_mov_b32 s30, 1024000
    s_mov_b32 s31, 0x20000
    s_mov_b32 s6, 0x38000000
    s_cmp_ge_u32 s41, 8
    s_mov_b32 s4, 0x4038aa3b
    s_cselect_b32 s4, 0xbfb8aa3b, s4
    s_cselect_b32 s44, 0x47000000, -2.0
    s_cselect_b32 s45, 0, 1.0
    s_cselect_b32 s54, s64, 0
    v_mov_b32 v30, s44
    v_mov_b32 v31, s45
    s_setprio 2
    s_branch L_b0
.p2align 12
L_hp:
    s_barrier
    buffer_load_dwordx4 v[128:131], v15, s[24:27], s14 offen
    buffer_load_dwordx4 v[132:135], v15, s[24:27], s14 offen offset:1024
    buffer_load_dwordx4 v[136:139], v15, s[24:27], s14 offen offset:2048
    buffer_load_dwordx4 v[140:143], v15, s[24:27], s14 offen offset:3072
    buffer_load_dwordx4 v[144:147], v15, s[24:27], s15 offen
    buffer_load_dwordx4 v[148:151], v15, s[24:27], s15 offen offset:1024
    buffer_load_dwordx4 v[152:155], v15, s[24:27], s15 offen offset:2048
    buffer_load_dwordx4 v[156:159], v15, s[24:27], s15 offen offset:3072
    s_waitcnt vmcnt(24)
.p2align 3
    v_perm_b32 v224, v36, v32, s47
    v_perm_b32 v228, v36, v32, s48
    v_perm_b32 v232, v37, v33, s47
    v_perm_b32 v236, v37, v33, s48
    v_perm_b32 v240, v38, v34, s47
    v_perm_b32 v244, v38, v34, s48
    v_perm_b32 v248, v39, v35, s47
    v_perm_b32 v252, v39, v35, s48
.p2align 3
    v_perm_b32 v225, v44, v40, s47
    v_perm_b32 v229, v44, v40, s48
    v_perm_b32 v233, v45, v41, s47
    v_perm_b32 v237, v45, v41, s48
    v_perm_b32 v241, v46, v42, s47
    v_perm_b32 v245, v46, v42, s48
    v_perm_b32 v249, v47, v43, s47
    v_perm_b32 v253, v47, v43, s48
.p2align 3
    v_perm_b32 v226, v52, v48, s47
    v_perm_b32 v230, v52, v48, s48
    v_perm_b32 v234, v53, v49, s47
    v_perm_b32 v238, v53, v49, s48
    v_perm_b32 v242, v54, v50, s47
    v_perm_b32 v246, v54, v50, s48
    v_perm_b32 v250, v55, v51, s47
    v_perm_b32 v254, v55, v51, s48
.p2align 3
    v_perm_b32 v227, v60, v56, s47
    v_perm_b32 v231, v60, v56, s48
    v_perm_b32 v235, v61, v57, s47
    v_perm_b32 v239, v61, v57, s48
    v_perm_b32 v243, v62, v58, s47
    v_perm_b32 v247, v62, v58, s48
    v_perm_b32 v251, v63, v59, s47
    v_perm_b32 v255, v63, v59, s48
    s_waitcnt vmcnt(16)
.p2align 3
    v_perm_b32 v32, v68, v64, s47
    v_perm_b32 v36, v68, v64, s48
    v_perm_b32 v40, v69, v65, s47
    v_perm_b32 v44, v69, v65, s48
    v_perm_b32 v48, v70, v66, s47
    v_perm_b32 v52, v70, v66, s48
    v_perm_b32 v56, v71, v67, s47
    v_perm_b32 v60, v71, v67, s48
.p2align 3
    v_perm_b32 v33, v76, v72, s47
    v_perm_b32 v37, v76, v72, s48
    v_perm_b32 v41, v77, v73, s47
    v_perm_b32 v45, v77, v73, s48
    v_perm_b32 v49, v78, v74, s47
    v_perm_b32 v53, v78, v74, s48
    v_perm_b32 v57, v79, v75, s47
    v_perm_b32 v61, v79, v75, s48
.p2align 3
    v_perm_b32 v34, v84, v80, s47
    v_perm_b32 v38, v84, v80, s48
    v_perm_b32 v42, v85, v81, s47
    v_perm_b32 v46, v85, v81, s48
    v_perm_b32 v50, v86, v82, s47
    v_perm_b32 v54, v86, v82, s48
    v_perm_b32 v58, v87, v83, s47
    v_perm_b32 v62, v87, v83, s48
.p2align 3
    v_perm_b32 v35, v92, v88, s47
    v_perm_b32 v39, v92, v88, s48
    v_perm_b32 v43, v93, v89, s47
    v_perm_b32 v47, v93, v89, s48
    v_perm_b32 v51, v94, v90, s47
    v_perm_b32 v55, v94, v90, s48
    v_perm_b32 v59, v95, v91, s47
    v_perm_b32 v63, v95, v91, s48
    s_waitcnt vmcnt(8)
.p2align 3
    v_perm_b32 v64, v100, v96, s47
    v_perm_b32 v68, v100, v96, s48
    v_perm_b32 v72, v101, v97, s47
    v_perm_b32 v76, v101, v97, s48
    v_perm_b32 v80, v102, v98, s47
    v_perm_b32 v84, v102, v98, s48
    v_perm_b32 v88, v103, v99, s47
    v_perm_b32 v92, v103, v99, s48
.p2align 3
    v_perm_b32 v65, v108, v104, s47
    v_perm_b32 v69, v108, v104, s48
    v_perm_b32 v73, v109, v105, s47
    v_perm_b32 v77, v109, v105, s48
    v_perm_b32 v81, v110, v106, s47
    v_perm_b32 v85, v110, v106, s48
    v_perm_b32 v89, v111, v107, s47
    v_perm_b32 v93, v111, v107, s48
.p2align 3
    v_perm_b32 v66, v116, v112, s47
    v_perm_b32 v70, v116, v112, s48
    v_perm_b32 v74, v117, v113, s47
    v_perm_b32 v78, v117, v113, s48
    v_perm_b32 v82, v118, v114, s47
    v_perm_b32 v86, v118, v114, s48
    v_perm_b32 v90, v119, v115, s47
    v_perm_b32 v94, v119, v115, s48
.p2align 3
    v_perm_b32 v67, v124, v120, s47
    v_perm_b32 v71, v124, v120, s48
    v_perm_b32 v75, v125, v121, s47
    v_perm_b32 v79, v125, v121, s48
    v_perm_b32 v83, v126, v122, s47
    v_perm_b32 v87, v126, v122, s48
    v_perm_b32 v91, v127, v123, s47
    v_perm_b32 v95, v127, v123, s48
    s_barrier
    buffer_load_dwordx4 v[160:163], v5, s[36:39], s32 offen sc1
    buffer_load_dwordx4 v[164:167], v5, s[36:39], s34 offen sc1
    s_barrier
    buffer_load_dwordx4 v[168:171], v14, s[36:39], s32 offen sc1
    buffer_load_dwordx4 v[172:175], v14, s[36:39], s34 offen sc1
    s_barrier
    buffer_load_dwordx4 v[176:179], v5, s[36:39], s33 offen sc1
    buffer_load_dwordx4 v[180:183], v5, s[36:39], s35 offen sc1
    s_barrier
    buffer_load_dwordx4 v[184:187], v14, s[36:39], s33 offen sc1
    buffer_load_dwordx4 v[188:191], v14, s[36:39], s35 offen sc1
    s_waitcnt vmcnt(8)
.p2align 3
    v_perm_b32 v96, v132, v128, s47
    v_perm_b32 v100, v132, v128, s48
    v_perm_b32 v104, v133, v129, s47
    v_perm_b32 v108, v133, v129, s48
    v_perm_b32 v112, v134, v130, s47
    v_perm_b32 v116, v134, v130, s48
    v_perm_b32 v120, v135, v131, s47
    v_perm_b32 v124, v135, v131, s48
.p2align 3
    v_perm_b32 v97, v140, v136, s47
    v_perm_b32 v101, v140, v136, s48
    v_perm_b32 v105, v141, v137, s47
    v_perm_b32 v109, v141, v137, s48
    v_perm_b32 v113, v142, v138, s47
    v_perm_b32 v117, v142, v138, s48
    v_perm_b32 v121, v143, v139, s47
    v_perm_b32 v125, v143, v139, s48
.p2align 3
    v_perm_b32 v98, v148, v144, s47
    v_perm_b32 v102, v148, v144, s48
    v_perm_b32 v106, v149, v145, s47
    v_perm_b32 v110, v149, v145, s48
    v_perm_b32 v114, v150, v146, s47
    v_perm_b32 v118, v150, v146, s48
    v_perm_b32 v122, v151, v147, s47
    v_perm_b32 v126, v151, v147, s48
.p2align 3
    v_perm_b32 v99, v156, v152, s47
    v_perm_b32 v103, v156, v152, s48
    v_perm_b32 v107, v157, v153, s47
    v_perm_b32 v111, v157, v153, s48
    v_perm_b32 v115, v158, v154, s47
    v_perm_b32 v119, v158, v154, s48
    v_perm_b32 v123, v159, v155, s47
    v_perm_b32 v127, v159, v155, s48
    s_waitcnt vmcnt(6)
    v_xor_b32 v160, v160, v3
    v_xor_b32 v164, v164, v3
    v_bitop3_b32 v0, v160, v164, s64 bitop3:0xa2
    v_cmp_ne_u32 vcc, 0, v0
    v_fma_mix_f32 v26, v161, v165, 0 op_sel_hi:[1,1,0]
    v_fma_mix_f32 v27, v161, v165, 0 op_sel:[1,1,0] op_sel_hi:[1,1,0]
    s_cbranch_vccnz L_re00
L_ok00:
    v_fma_mix_f32 v28, v162, v166, 0 op_sel_hi:[1,1,0]
    v_fma_mix_f32 v29, v162, v166, 0 op_sel:[1,1,0] op_sel_hi:[1,1,0]
    v_fma_mix_f32 v30, v163, v167, 0 op_sel_hi:[1,1,0]
    v_fma_mix_f32 v31, v163, v167, 0 op_sel:[1,1,0] op_sel_hi:[1,1,0]
    v_fma_mix_f32 v24, v160, v164, 0 op_sel_hi:[1,1,0]
    v_fma_mix_f32 v25, v160, v164, 0 op_sel:[1,1,0] op_sel_hi:[1,1,0]
    v_cvt_pk_bf16_f32 v161, v26, v27
    v_cvt_pk_bf16_f32 v162, v28, v29
    v_cvt_pk_bf16_f32 v163, v30, v31
    v_cvt_pk_bf16_f32 v160, v24, v25
    s_nop 1
    v_mfma_f32_16x16x32_bf16 v[192:195], v[160:163], v[224:227], 0
    buffer_load_dwordx4 v[128:131], v5, s[36:39], s67 offen sc1
    buffer_load_dwordx4 v[132:135], v5, s[36:39], s69 offen sc1
    s_waitcnt vmcnt(6)
    v_xor_b32 v168, v168, v3
    v_mfma_f32_16x16x32_bf16 v[196:199], v[160:163], v[228:231], 0
    buffer_load_dwordx4 v[136:139], v14, s[36:39], s67 offen sc1
    buffer_load_dwordx4 v[140:143], v14, s[36:39], s69 offen sc1
    v_xor_b32 v172, v172, v3
    v_bitop3_b32 v0, v168, v172, s64 bitop3:0xa2
    v_mfma_f32_16x16x32_bf16 v[200:203], v[160:163], v[232:235], 0
    v_cmp_ne_u32 vcc, 0, v0
    v_fma_mix_f32 v26, v169, v173, 0 op_sel_hi:[1,1,0]
    v_fma_mix_f32 v27, v169, v173, 0 op_sel:[1,1,0] op_sel_hi:[1,1,0]
    s_cbranch_vccnz L_re01
L_ok01:
    v_mfma_f32_16x16x32_bf16 v[204:207], v[160:163], v[236:239], 0
    v_fma_mix_f32 v28, v170, v174, 0 op_sel_hi:[1,1,0]
    v_fma_mix_f32 v29, v170, v174, 0 op_sel:[1,1,0] op_sel_hi:[1,1,0]
    v_fma_mix_f32 v30, v171, v175, 0 op_sel_hi:[1,1,0]
    v_mfma_f32_16x16x32_bf16 v[208:211], v[160:163], v[240:243], 0
    v_fma_mix_f32 v31, v171, v175, 0 op_sel:[1,1,0] op_sel_hi:[1,1,0]
    v_fma_mix_f32 v24, v168, v172, 0 op_sel_hi:[1,1,0]
    v_fma_mix_f32 v25, v168, v172, 0 op_sel:[1,1,0] op_sel_hi:[1,1,0]
    v_cvt_pk_bf16_f32 v169, v26, v27
    v_mfma_f32_16x16x32_bf16 v[212:215], v[160:163], v[244:247], 0
    v_cvt_pk_bf16_f32 v170, v28, v29
    v_cvt_pk_bf16_f32 v171, v30, v31
    v_cvt_pk_bf16_f32 v168, v24, v25
    v_mfma_f32_16x16x32_bf16 v[216:219], v[160:163], v[248:251], 0
    s_waitcnt vmcnt(6)
    v_xor_b32 v176, v176, v3
    v_xor_b32 v180, v180, v3
    v_bitop3_b32 v0, v176, v180, s64 bitop3:0xa2
    v_mfma_f32_16x16x32_bf16 v[220:223], v[160:163], v[252:255], 0
    v_cmp_ne_u32 vcc, 0, v0
    v_fma_mix_f32 v26, v177, v181, 0 op_sel_hi:[1,1,0]
    v_fma_mix_f32 v27, v177, v181, 0 op_sel:[1,1,0] op_sel_hi:[1,1,0]
    s_cbranch_vccnz L_re02
L_ok02:
    v_mfma_f32_16x16x32_bf16 v[192:195], v[168:171], v[32:35], v[192:195]
    buffer_load_dwordx4 v[144:147], v5, s[36:39], s68 offen sc1
    buffer_load_dwordx4 v[148:151], v5, s[36:39], s70 offen sc1
    v_fma_mix_f32 v28, v178, v182, 0 op_sel_hi:[1,1,0]
    v_fma_mix_f32 v29, v178, v182, 0 op_sel:[1,1,0] op_sel_hi:[1,1,0]
    v_mfma_f32_16x16x32_bf16 v[196:199], v[168:171], v[36:39], v[196:199]
    v_fma_mix_f32 v30, v179, v183, 0 op_sel_hi:[1,1,0]
    v_fma_mix_f32 v31, v179, v183, 0 op_sel:[1,1,0] op_sel_hi:[1,1,0]
    v_fma_mix_f32 v24, v176, v180, 0 op_sel_hi:[1,1,0]
    v_fma_mix_f32 v25, v176, v180, 0 op_sel:[1,1,0] op_sel_hi:[1,1,0]
    v_mfma_f32_16x16x32_bf16 v[200:203], v[168:171], v[40:43], v[200:203]
    v_cvt_pk_bf16_f32 v177, v26, v27
    v_cvt_pk_bf16_f32 v178, v28, v29
    v_cvt_pk_bf16_f32 v179, v30, v31
    v_cvt_pk_bf16_f32 v176, v24, v25
    v_mfma_f32_16x16x32_bf16 v[204:207], v[168:171], v[44:47], v[204:207]
    s_waitcnt vmcnt(6)
    v_xor_b32 v184, v184, v3
    v_xor_b32 v188, v188, v3
    v_bitop3_b32 v0, v184, v188, s64 bitop3:0xa2
    v_mfma_f32_16x16x32_bf16 v[208:211], v[168:171], v[48:51], v[208:211]
    v_cmp_ne_u32 vcc, 0, v0
    v_fma_mix_f32 v26, v185, v189, 0 op_sel_hi:[1,1,0]
    v_fma_mix_f32 v27, v185, v189, 0 op_sel:[1,1,0] op_sel_hi:[1,1,0]
    v_mfma_f32_16x16x32_bf16 v[212:215], v[168:171], v[52:55], v[212:215]
    s_cbranch_vccnz L_re03
L_ok03:
    v_fma_mix_f32 v28, v186, v190, 0 op_sel_hi:[1,1,0]
    v_fma_mix_f32 v29, v186, v190, 0 op_sel:[1,1,0] op_sel_hi:[1,1,0]
    v_fma_mix_f32 v30, v187, v191, 0 op_sel_hi:[1,1,0]
    v_mfma_f32_16x16x32_bf16 v[216:219], v[168:171], v[56:59], v[216:219]
    v_fma_mix_f32 v31, v187, v191, 0 op_sel:[1,1,0] op_sel_hi:[1,1,0]
    v_fma_mix_f32 v24, v184, v188, 0 op_sel_hi:[1,1,0]
    v_fma_mix_f32 v25, v184, v188, 0 op_sel:[1,1,0] op_sel_hi:[1,1,0]
    v_mfma_f32_16x16x32_bf16 v[220:223], v[168:171], v[60:63], v[220:223]
    v_cvt_pk_bf16_f32 v185, v26, v27
    v_cvt_pk_bf16_f32 v186, v28, v29
    v_cvt_pk_bf16_f32 v187, v30, v31
    v_mfma_f32_16x16x32_bf16 v[192:195], v[176:179], v[64:67], v[192:195]
    buffer_load_dwordx4 v[152:155], v14, s[36:39], s68 offen sc1
    buffer_load_dwordx4 v[156:159], v14, s[36:39], s70 offen sc1
    v_cvt_pk_bf16_f32 v184, v24, v25
    s_nop 1
    v_mfma_f32_16x16x32_bf16 v[192:195], v[184:187], v[96:99], v[192:195]
    v_mfma_f32_16x16x32_bf16 v[196:199], v[176:179], v[68:71], v[196:199]
    v_mfma_f32_16x16x32_bf16 v[196:199], v[184:187], v[100:103], v[196:199]
    ds_write_b128 v8, v[192:195] offset:0
    v_mfma_f32_16x16x32_bf16 v[200:203], v[176:179], v[72:75], v[200:203]
    v_mfma_f32_16x16x32_bf16 v[200:203], v[184:187], v[104:107], v[200:203]
    ds_write_b128 v8, v[196:199] offset:1024
    v_mfma_f32_16x16x32_bf16 v[204:207], v[176:179], v[76:79], v[204:207]
    v_mfma_f32_16x16x32_bf16 v[204:207], v[184:187], v[108:111], v[204:207]
    ds_write_b128 v8, v[200:203] offset:2048
    s_waitcnt vmcnt(6)
    v_mfma_f32_16x16x32_bf16 v[208:211], v[176:179], v[80:83], v[208:211]
    v_xor_b32 v128, v128, v3
    v_xor_b32 v132, v132, v3
    v_bitop3_b32 v0, v128, v132, s64 bitop3:0xa2
    v_cmp_ne_u32 vcc, 0, v0
    v_mfma_f32_16x16x32_bf16 v[208:211], v[184:187], v[112:115], v[208:211]
    ds_write_b128 v8, v[204:207] offset:3072
    v_mfma_f32_16x16x32_bf16 v[212:215], v[176:179], v[84:87], v[212:215]
    v_fma_mix_f32 v26, v129, v133, 0 op_sel_hi:[1,1,0]
    v_fma_mix_f32 v27, v129, v133, 0 op_sel:[1,1,0] op_sel_hi:[1,1,0]
    s_cbranch_vccnz L_re10
L_ok10:
    v_fma_mix_f32 v28, v130, v134, 0 op_sel_hi:[1,1,0]
    v_mfma_f32_16x16x32_bf16 v[212:215], v[184:187], v[116:119], v[212:215]
    ds_write_b128 v8, v[208:211] offset:4096
    v_mfma_f32_16x16x32_bf16 v[216:219], v[176:179], v[88:91], v[216:219]
    v_fma_mix_f32 v29, v130, v134, 0 op_sel:[1,1,0] op_sel_hi:[1,1,0]
    v_fma_mix_f32 v30, v131, v135, 0 op_sel_hi:[1,1,0]
    v_fma_mix_f32 v31, v131, v135, 0 op_sel:[1,1,0] op_sel_hi:[1,1,0]
    v_fma_mix_f32 v24, v128, v132, 0 op_sel_hi:[1,1,0]
    v_mfma_f32_16x16x32_bf16 v[216:219], v[184:187], v[120:123], v[216:219]
    ds_write_b128 v8, v[212:215] offset:5120
    v_mfma_f32_16x16x32_bf16 v[220:223], v[176:179], v[92:95], v[220:223]
    v_fma_mix_f32 v25, v128, v132, 0 op_sel:[1,1,0] op_sel_hi:[1,1,0]
    v_cvt_pk_bf16_f32 v129, v26, v27
    v_cvt_pk_bf16_f32 v130, v28, v29
    v_cvt_pk_bf16_f32 v131, v30, v31
    v_mfma_f32_16x16x32_bf16 v[220:223], v[184:187], v[124:127], v[220:223]
    ds_write_b128 v8, v[216:219] offset:6144
    v_cvt_pk_bf16_f32 v128, v24, v25
    s_nop 1
    v_mfma_f32_16x16x32_bf16 v[160:163], v[128:131], v[224:227], 0
    s_waitcnt vmcnt(4)
    v_xor_b32 v136, v136, v3
    v_xor_b32 v140, v140, v3
    v_bitop3_b32 v0, v136, v140, s64 bitop3:0xa2
    v_mfma_f32_16x16x32_bf16 v[164:167], v[128:131], v[228:231], 0
    ds_write_b128 v8, v[220:223] offset:7168
    v_mfma_f32_16x16x32_bf16 v[168:171], v[128:131], v[232:235], 0
    v_cmp_ne_u32 vcc, 0, v0
    v_fma_mix_f32 v26, v137, v141, 0 op_sel_hi:[1,1,0]
    v_fma_mix_f32 v27, v137, v141, 0 op_sel:[1,1,0] op_sel_hi:[1,1,0]
    s_cbranch_vccnz L_re11
L_ok11:
    v_mfma_f32_16x16x32_bf16 v[172:175], v[128:131], v[236:239], 0
    v_fma_mix_f32 v28, v138, v142, 0 op_sel_hi:[1,1,0]
    v_fma_mix_f32 v29, v138, v142, 0 op_sel:[1,1,0] op_sel_hi:[1,1,0]
    v_fma_mix_f32 v30, v139, v143, 0 op_sel_hi:[1,1,0]
    v_fma_mix_f32 v31, v139, v143, 0 op_sel:[1,1,0] op_sel_hi:[1,1,0]
    v_mfma_f32_16x16x32_bf16 v[176:179], v[128:131], v[240:243], 0
    s_waitcnt lgkmcnt(0)
    s_barrier
    v_fma_mix_f32 v24, v136, v140, 0 op_sel_hi:[1,1,0]
    v_fma_mix_f32 v25, v136, v140, 0 op_sel:[1,1,0] op_sel_hi:[1,1,0]
    v_cvt_pk_bf16_f32 v137, v26, v27
    v_mfma_f32_16x16x32_bf16 v[180:183], v[128:131], v[244:247], 0
    v_cvt_pk_bf16_f32 v138, v28, v29
    v_cvt_pk_bf16_f32 v139, v30, v31
    v_cvt_pk_bf16_f32 v136, v24, v25
    v_mfma_f32_16x16x32_bf16 v[184:187], v[128:131], v[248:251], 0
    s_waitcnt vmcnt(2)
    v_xor_b32 v144, v144, v3
    v_xor_b32 v148, v148, v3
    v_bitop3_b32 v0, v144, v148, s64 bitop3:0xa2
    v_mfma_f32_16x16x32_bf16 v[188:191], v[128:131], v[252:255], 0
    v_cmp_ne_u32 vcc, 0, v0
    v_fma_mix_f32 v26, v145, v149, 0 op_sel_hi:[1,1,0]
    v_fma_mix_f32 v27, v145, v149, 0 op_sel:[1,1,0] op_sel_hi:[1,1,0]
    s_cbranch_vccnz L_re12
L_ok12:
    v_mfma_f32_16x16x32_bf16 v[160:163], v[136:139], v[32:35], v[160:163]
    v_fma_mix_f32 v28, v146, v150, 0 op_sel_hi:[1,1,0]
    v_fma_mix_f32 v29, v146, v150, 0 op_sel:[1,1,0] op_sel_hi:[1,1,0]
    v_fma_mix_f32 v30, v147, v151, 0 op_sel_hi:[1,1,0]
    v_mfma_f32_16x16x32_bf16 v[164:167], v[136:139], v[36:39], v[164:167]
    v_fma_mix_f32 v31, v147, v151, 0 op_sel:[1,1,0] op_sel_hi:[1,1,0]
    v_fma_mix_f32 v24, v144, v148, 0 op_sel_hi:[1,1,0]
    v_fma_mix_f32 v25, v144, v148, 0 op_sel:[1,1,0] op_sel_hi:[1,1,0]
    v_mfma_f32_16x16x32_bf16 v[168:171], v[136:139], v[40:43], v[168:171]
    v_cvt_pk_bf16_f32 v145, v26, v27
    v_cvt_pk_bf16_f32 v146, v28, v29
    v_cvt_pk_bf16_f32 v147, v30, v31
    v_cvt_pk_bf16_f32 v144, v24, v25
    v_mfma_f32_16x16x32_bf16 v[172:175], v[136:139], v[44:47], v[172:175]
    s_waitcnt vmcnt(0)
    v_xor_b32 v152, v152, v3
    v_xor_b32 v156, v156, v3
    v_mfma_f32_16x16x32_bf16 v[176:179], v[136:139], v[48:51], v[176:179]
    v_bitop3_b32 v0, v152, v156, s64 bitop3:0xa2
    v_cmp_ne_u32 vcc, 0, v0
    v_fma_mix_f32 v26, v153, v157, 0 op_sel_hi:[1,1,0]
    v_mfma_f32_16x16x32_bf16 v[180:183], v[136:139], v[52:55], v[180:183]
    v_fma_mix_f32 v27, v153, v157, 0 op_sel:[1,1,0] op_sel_hi:[1,1,0]
    s_cbranch_vccnz L_re13
L_ok13:
    v_fma_mix_f32 v28, v154, v158, 0 op_sel_hi:[1,1,0]
    v_mfma_f32_16x16x32_bf16 v[184:187], v[136:139], v[56:59], v[184:187]
    v_fma_mix_f32 v29, v154, v158, 0 op_sel:[1,1,0] op_sel_hi:[1,1,0]
    v_fma_mix_f32 v30, v155, v159, 0 op_sel_hi:[1,1,0]
    v_fma_mix_f32 v31, v155, v159, 0 op_sel:[1,1,0] op_sel_hi:[1,1,0]
    v_mfma_f32_16x16x32_bf16 v[188:191], v[136:139], v[60:63], v[188:191]
    v_fma_mix_f32 v24, v152, v156, 0 op_sel_hi:[1,1,0]
    v_fma_mix_f32 v25, v152, v156, 0 op_sel:[1,1,0] op_sel_hi:[1,1,0]
    v_cvt_pk_bf16_f32 v153, v26, v27
    v_mfma_f32_16x16x32_bf16 v[160:163], v[144:147], v[64:67], v[160:163]
    v_cvt_pk_bf16_f32 v154, v28, v29
    v_cvt_pk_bf16_f32 v155, v30, v31
    v_cvt_pk_bf16_f32 v152, v24, v25
    s_nop 1
    v_mfma_f32_16x16x32_bf16 v[160:163], v[152:155], v[96:99], v[160:163]
    v_mfma_f32_16x16x32_bf16 v[164:167], v[144:147], v[68:71], v[164:167]
    v_mfma_f32_16x16x32_bf16 v[164:167], v[152:155], v[100:103], v[164:167]
    ds_write_b128 v8, v[160:163] offset:32768
    v_mfma_f32_16x16x32_bf16 v[168:171], v[144:147], v[72:75], v[168:171]
    v_mfma_f32_16x16x32_bf16 v[168:171], v[152:155], v[104:107], v[168:171]
    ds_write_b128 v8, v[164:167] offset:33792
    v_mfma_f32_16x16x32_bf16 v[172:175], v[144:147], v[76:79], v[172:175]
    v_mfma_f32_16x16x32_bf16 v[172:175], v[152:155], v[108:111], v[172:175]
    ds_write_b128 v8, v[168:171] offset:34816
    v_mfma_f32_16x16x32_bf16 v[176:179], v[144:147], v[80:83], v[176:179]
    v_mfma_f32_16x16x32_bf16 v[176:179], v[152:155], v[112:115], v[176:179]
    ds_write_b128 v8, v[172:175] offset:35840
    v_mfma_f32_16x16x32_bf16 v[180:183], v[144:147], v[84:87], v[180:183]
    v_mfma_f32_16x16x32_bf16 v[180:183], v[152:155], v[116:119], v[180:183]
    ds_write_b128 v8, v[176:179] offset:36864
    v_mfma_f32_16x16x32_bf16 v[184:187], v[144:147], v[88:91], v[184:187]
    v_mfma_f32_16x16x32_bf16 v[184:187], v[152:155], v[120:123], v[184:187]
    ds_write_b128 v8, v[180:183] offset:37888
    v_mfma_f32_16x16x32_bf16 v[188:191], v[144:147], v[92:95], v[188:191]
    v_mfma_f32_16x16x32_bf16 v[188:191], v[152:155], v[124:127], v[188:191]
    ds_write_b128 v8, v[184:187] offset:38912
    s_nop 6
    ds_write_b128 v8, v[188:191] offset:39936
    s_waitcnt lgkmcnt(0)
    s_barrier
    s_endpgm
L_re00:
    s_add_u32 s71, s71, 1
    s_cmp_ge_u32 s71, 20000
    s_cbranch_scc1 L_end
    buffer_load_dwordx4 v[160:163], v5, s[36:39], s32 offen sc1
    buffer_load_dwordx4 v[164:167], v5, s[36:39], s34 offen sc1
    buffer_load_dwordx4 v[168:171], v14, s[36:39], s32 offen sc1
    buffer_load_dwordx4 v[172:175], v14, s[36:39], s34 offen sc1
    buffer_load_dwordx4 v[176:179], v5, s[36:39], s33 offen sc1
    buffer_load_dwordx4 v[180:183], v5, s[36:39], s35 offen sc1
    buffer_load_dwordx4 v[184:187], v14, s[36:39], s33 offen sc1
    buffer_load_dwordx4 v[188:191], v14, s[36:39], s35 offen sc1
    s_waitcnt vmcnt(0)
    v_xor_b32 v160, v160, v3
    v_xor_b32 v164, v164, v3
    v_bitop3_b32 v0, v160, v164, s64 bitop3:0xa2
    v_cmp_ne_u32 vcc, 0, v0
    v_fma_mix_f32 v26, v161, v165, 0 op_sel_hi:[1,1,0]
    v_fma_mix_f32 v27, v161, v165, 0 op_sel:[1,1,0] op_sel_hi:[1,1,0]
    s_cbranch_vccnz L_re00
    s_branch L_ok00
L_re01:
    s_add_u32 s71, s71, 1
    s_cmp_ge_u32 s71, 20000
    s_cbranch_scc1 L_end
    buffer_load_dwordx4 v[168:171], v14, s[36:39], s32 offen sc1
    buffer_load_dwordx4 v[172:175], v14, s[36:39], s34 offen sc1
    buffer_load_dwordx4 v[176:179], v5, s[36:39], s33 offen sc1
    buffer_load_dwordx4 v[180:183], v5, s[36:39], s35 offen sc1
    buffer_load_dwordx4 v[184:187], v14, s[36:39], s33 offen sc1
    buffer_load_dwordx4 v[188:191], v14, s[36:39], s35 offen sc1
    s_waitcnt vmcnt(0)
    v_xor_b32 v168, v168, v3
    v_xor_b32 v172, v172, v3
    v_bitop3_b32 v0, v168, v172, s64 bitop3:0xa2
    v_cmp_ne_u32 vcc, 0, v0
    v_fma_mix_f32 v26, v169, v173, 0 op_sel_hi:[1,1,0]
    v_fma_mix_f32 v27, v169, v173, 0 op_sel:[1,1,0] op_sel_hi:[1,1,0]
    s_cbranch_vccnz L_re01
    s_branch L_ok01
L_re02:
    s_add_u32 s71, s71, 1
    s_cmp_ge_u32 s71, 20000
    s_cbranch_scc1 L_end
    buffer_load_dwordx4 v[176:179], v5, s[36:39], s33 offen sc1
    buffer_load_dwordx4 v[180:183], v5, s[36:39], s35 offen sc1
    buffer_load_dwordx4 v[184:187], v14, s[36:39], s33 offen sc1
    buffer_load_dwordx4 v[188:191], v14, s[36:39], s35 offen sc1
    s_waitcnt vmcnt(0)
    v_xor_b32 v176, v176, v3
    v_xor_b32 v180, v180, v3
    v_bitop3_b32 v0, v176, v180, s64 bitop3:0xa2
    v_cmp_ne_u32 vcc, 0, v0
    v_fma_mix_f32 v26, v177, v181, 0 op_sel_hi:[1,1,0]
    v_fma_mix_f32 v27, v177, v181, 0 op_sel:[1,1,0] op_sel_hi:[1,1,0]
    s_cbranch_vccnz L_re02
    s_branch L_ok02
L_re03:
    s_add_u32 s71, s71, 1
    s_cmp_ge_u32 s71, 20000
    s_cbranch_scc1 L_end
    buffer_load_dwordx4 v[184:187], v14, s[36:39], s33 offen sc1
    buffer_load_dwordx4 v[188:191], v14, s[36:39], s35 offen sc1
    s_waitcnt vmcnt(0)
    v_xor_b32 v184, v184, v3
    v_xor_b32 v188, v188, v3
    v_bitop3_b32 v0, v184, v188, s64 bitop3:0xa2
    v_cmp_ne_u32 vcc, 0, v0
    v_fma_mix_f32 v26, v185, v189, 0 op_sel_hi:[1,1,0]
    v_fma_mix_f32 v27, v185, v189, 0 op_sel:[1,1,0] op_sel_hi:[1,1,0]
    s_cbranch_vccnz L_re03
    s_branch L_ok03
L_re10:
    s_add_u32 s71, s71, 1
    s_cmp_ge_u32 s71, 20000
    s_cbranch_scc1 L_end
    buffer_load_dwordx4 v[128:131], v5, s[36:39], s67 offen sc1
    buffer_load_dwordx4 v[132:135], v5, s[36:39], s69 offen sc1
    buffer_load_dwordx4 v[136:139], v14, s[36:39], s67 offen sc1
    buffer_load_dwordx4 v[140:143], v14, s[36:39], s69 offen sc1
    buffer_load_dwordx4 v[144:147], v5, s[36:39], s68 offen sc1
    buffer_load_dwordx4 v[148:151], v5, s[36:39], s70 offen sc1
    buffer_load_dwordx4 v[152:155], v14, s[36:39], s68 offen sc1
    buffer_load_dwordx4 v[156:159], v14, s[36:39], s70 offen sc1
    s_waitcnt vmcnt(0)
    v_xor_b32 v128, v128, v3
    v_xor_b32 v132, v132, v3
    v_bitop3_b32 v0, v128, v132, s64 bitop3:0xa2
    v_cmp_ne_u32 vcc, 0, v0
    v_fma_mix_f32 v26, v129, v133, 0 op_sel_hi:[1,1,0]
    v_fma_mix_f32 v27, v129, v133, 0 op_sel:[1,1,0] op_sel_hi:[1,1,0]
    s_cbranch_vccnz L_re10
    s_branch L_ok10
L_re11:
    s_add_u32 s71, s71, 1
    s_cmp_ge_u32 s71, 20000
    s_cbranch_scc1 L_end
    buffer_load_dwordx4 v[136:139], v14, s[36:39], s67 offen sc1
    buffer_load_dwordx4 v[140:143], v14, s[36:39], s69 offen sc1
    buffer_load_dwordx4 v[144:147], v5, s[36:39], s68 offen sc1
    buffer_load_dwordx4 v[148:151], v5, s[36:39], s70 offen sc1
    buffer_load_dwordx4 v[152:155], v14, s[36:39], s68 offen sc1
    buffer_load_dwordx4 v[156:159], v14, s[36:39], s70 offen sc1
    s_waitcnt vmcnt(0)
    v_xor_b32 v136, v136, v3
    v_xor_b32 v140, v140, v3
    v_bitop3_b32 v0, v136, v140, s64 bitop3:0xa2
    v_cmp_ne_u32 vcc, 0, v0
    v_fma_mix_f32 v26, v137, v141, 0 op_sel_hi:[1,1,0]
    v_fma_mix_f32 v27, v137, v141, 0 op_sel:[1,1,0] op_sel_hi:[1,1,0]
    s_cbranch_vccnz L_re11
    s_branch L_ok11
L_re12:
    s_add_u32 s71, s71, 1
    s_cmp_ge_u32 s71, 20000
    s_cbranch_scc1 L_end
    buffer_load_dwordx4 v[144:147], v5, s[36:39], s68 offen sc1
    buffer_load_dwordx4 v[148:151], v5, s[36:39], s70 offen sc1
    buffer_load_dwordx4 v[152:155], v14, s[36:39], s68 offen sc1
    buffer_load_dwordx4 v[156:159], v14, s[36:39], s70 offen sc1
    s_waitcnt vmcnt(0)
    v_xor_b32 v144, v144, v3
    v_xor_b32 v148, v148, v3
    v_bitop3_b32 v0, v144, v148, s64 bitop3:0xa2
    v_cmp_ne_u32 vcc, 0, v0
    v_fma_mix_f32 v26, v145, v149, 0 op_sel_hi:[1,1,0]
    v_fma_mix_f32 v27, v145, v149, 0 op_sel:[1,1,0] op_sel_hi:[1,1,0]
    s_cbranch_vccnz L_re12
    s_branch L_ok12
L_re13:
    s_add_u32 s71, s71, 1
    s_cmp_ge_u32 s71, 20000
    s_cbranch_scc1 L_end
    buffer_load_dwordx4 v[152:155], v14, s[36:39], s68 offen sc1
    buffer_load_dwordx4 v[156:159], v14, s[36:39], s70 offen sc1
    s_waitcnt vmcnt(0)
    v_xor_b32 v152, v152, v3
    v_xor_b32 v156, v156, v3
    v_bitop3_b32 v0, v152, v156, s64 bitop3:0xa2
    v_cmp_ne_u32 vcc, 0, v0
    v_fma_mix_f32 v26, v153, v157, 0 op_sel_hi:[1,1,0]
    v_fma_mix_f32 v27, v153, v157, 0 op_sel:[1,1,0] op_sel_hi:[1,1,0]
    s_cbranch_vccnz L_re13
    s_branch L_ok13
.fill 0, 4, 0xbf810000
.p2align 12
L_b0:
    s_barrier
    ds_read_b64_tr_b16 v[136:137], v7 offset:0
    ds_read_b64_tr_b16 v[138:139], v7 offset:512
    ds_read_b128 v[96:99], v3 offset:512
    ds_read_b64_tr_b16 v[144:145], v7 offset:8192
    ds_read_b64_tr_b16 v[146:147], v7 offset:8704
    ds_read_b128 v[92:95], v3 offset:256
    ds_read_b64_tr_b16 v[152:153], v7 offset:16384
    ds_read_b64_tr_b16 v[154:155], v7 offset:16896
    ds_read_b128 v[88:91], v3 offset:0
    ds_read_b64_tr_b16 v[156:157], v8 offset:16384
    ds_read_b64_tr_b16 v[158:159], v8 offset:16896
    ds_read_b64_tr_b16 v[148:149], v8 offset:8192
    ds_read_b64_tr_b16 v[150:151], v8 offset:8704
    ds_read_b64_tr_b16 v[140:141], v8 offset:0
    ds_read_b64_tr_b16 v[142:143], v8 offset:512
    ds_read_b128 v[100:103], v3 offset:768
L_loop:
    s_waitcnt lgkmcnt(13)
    v_mfma_f32_16x16x32_bf16 v[32:35], v[136:139], v[96:99], v[32:35]
    ds_read_b128 v[104:107], v5 offset:1024
    s_waitcnt lgkmcnt(11)
    v_mfma_f32_16x16x32_bf16 v[32:35], v[144:147], v[92:95], v[32:35]
    ds_read_b128 v[108:111], v5 offset:1280
    s_waitcnt lgkmcnt(9)
    v_mfma_f32_16x16x32_bf16 v[32:35], v[152:155], v[88:91], v[32:35]
    s_waitcnt lgkmcnt(7)
    v_mfma_f32_16x16x32_bf16 v[36:39], v[156:159], v[88:91], v[36:39]
    ds_read_b64_tr_b16 v[64:65], v7 offset:1024
    s_waitcnt lgkmcnt(6)
    v_mfma_f32_16x16x32_bf16 v[36:39], v[148:151], v[92:95], v[36:39]
    ds_read_b64_tr_b16 v[66:67], v7 offset:1536
    s_waitcnt lgkmcnt(5)
    v_mfma_f32_16x16x32_bf16 v[36:39], v[140:143], v[96:99], v[36:39]
    ds_read_b128 v[120:123], v4 offset:512
    s_waitcnt lgkmcnt(5)
    v_mfma_f32_16x16x32_bf16 v[44:47], v[140:143], v[100:103], v[44:47]
    v_mfma_f32_16x16x32_bf16 v[44:47], v[148:151], v[96:99], v[44:47]
    ds_read_b64_tr_b16 v[72:73], v7 offset:9216
    v_mfma_f32_16x16x32_bf16 v[44:47], v[156:159], v[92:95], v[44:47]
    ds_read_b64_tr_b16 v[74:75], v7 offset:9728
    v_mfma_f32_16x16x32_bf16 v[40:43], v[152:155], v[92:95], v[40:43]
    ds_read_b128 v[116:119], v4 offset:256
    v_mfma_f32_16x16x32_bf16 v[40:43], v[144:147], v[96:99], v[40:43]
    v_mfma_f32_16x16x32_bf16 v[40:43], v[136:139], v[100:103], v[40:43]
    ds_read_b64_tr_b16 v[80:81], v7 offset:17408
    s_waitcnt lgkmcnt(8)
    v_mfma_f32_16x16x32_bf16 v[48:51], v[136:139], v[104:107], v[48:51]
    ds_read_b64_tr_b16 v[82:83], v7 offset:17920
    v_mfma_f32_16x16x32_bf16 v[48:51], v[144:147], v[100:103], v[48:51]
    ds_read_b128 v[112:115], v4 offset:0
    v_mfma_f32_16x16x32_bf16 v[48:51], v[152:155], v[96:99], v[48:51]
    ds_read_b64_tr_b16 v[84:85], v8 offset:17408
    v_mfma_f32_16x16x32_bf16 v[52:55], v[156:159], v[96:99], v[52:55]
    v_mfma_f32_16x16x32_bf16 v[52:55], v[148:151], v[100:103], v[52:55]
    ds_read_b64_tr_b16 v[86:87], v8 offset:17920
    v_mfma_f32_16x16x32_bf16 v[52:55], v[140:143], v[104:107], v[52:55]
    ds_read_b64_tr_b16 v[76:77], v8 offset:9216
    s_waitcnt lgkmcnt(12)
    v_mfma_f32_16x16x32_bf16 v[60:63], v[140:143], v[108:111], v[60:63]
    ds_read_b64_tr_b16 v[78:79], v8 offset:9728
    v_mfma_f32_16x16x32_bf16 v[60:63], v[148:151], v[104:107], v[60:63]
    v_mfma_f32_16x16x32_bf16 v[60:63], v[156:159], v[100:103], v[60:63]
    ds_read_b64_tr_b16 v[68:69], v8 offset:1024
    v_mfma_f32_16x16x32_bf16 v[56:59], v[152:155], v[100:103], v[56:59]
    ds_read_b64_tr_b16 v[70:71], v8 offset:1536
    v_mfma_f32_16x16x32_bf16 v[56:59], v[144:147], v[104:107], v[56:59]
    ds_read_b128 v[124:127], v4 offset:768
    s_add_u32 s61, s61, 1
    v_mfma_f32_16x16x32_bf16 v[56:59], v[136:139], v[108:111], v[56:59]
    s_cmp_eq_u32 s61, 3
    s_cselect_b32 s60, 4294883328, s56
    s_cselect_b32 s61, 0, s61
    s_waitcnt lgkmcnt(7)
    v_mfma_f32_16x16x32_bf16 v[32:35], v[64:67], v[120:123], v[32:35]
    ds_read_b128 v[128:131], v6 offset:1024
    v_mfma_f32_16x16x32_bf16 v[32:35], v[72:75], v[116:119], v[32:35]
    ds_read_b128 v[132:135], v6 offset:1280
    v_mfma_f32_16x16x32_bf16 v[32:35], v[80:83], v[112:115], v[32:35]
    v_add_u32 v3, s60, v3
    v_add_u32 v5, s60, v5
    s_waitcnt lgkmcnt(3)
    v_mfma_f32_16x16x32_bf16 v[36:39], v[84:87], v[112:115], v[36:39]
    v_add_u32 v7, s60, v7
    v_add_u32 v8, s60, v8
    v_mfma_f32_16x16x32_bf16 v[36:39], v[76:79], v[116:119], v[36:39]
    v_add_u32 v4, s60, v4
    v_add_u32 v6, s60, v6
    v_mfma_f32_16x16x32_bf16 v[36:39], v[68:71], v[120:123], v[36:39]
    s_waitcnt lgkmcnt(2)
    v_mfma_f32_16x16x32_bf16 v[44:47], v[68:71], v[124:127], v[44:47]
    v_mfma_f32_16x16x32_bf16 v[44:47], v[76:79], v[120:123], v[44:47]
    v_mfma_f32_16x16x32_bf16 v[44:47], v[84:87], v[116:119], v[44:47]
    v_mfma_f32_16x16x32_bf16 v[40:43], v[80:83], v[116:119], v[40:43]
    s_waitcnt lgkmcnt(0)
    s_barrier
    v_mfma_f32_16x16x32_bf16 v[40:43], v[72:75], v[120:123], v[40:43]
    ds_read_b64_tr_b16 v[136:137], v7 offset:0
    ds_read_b64_tr_b16 v[138:139], v7 offset:512
    v_mfma_f32_16x16x32_bf16 v[40:43], v[64:67], v[124:127], v[40:43]
    ds_read_b128 v[96:99], v3 offset:512
    v_mfma_f32_16x16x32_bf16 v[48:51], v[64:67], v[128:131], v[48:51]
    ds_read_b64_tr_b16 v[144:145], v7 offset:8192
    ds_read_b64_tr_b16 v[146:147], v7 offset:8704
    v_mfma_f32_16x16x32_bf16 v[48:51], v[72:75], v[124:127], v[48:51]
    ds_read_b128 v[92:95], v3 offset:256
    v_mfma_f32_16x16x32_bf16 v[48:51], v[80:83], v[120:123], v[48:51]
    ds_read_b64_tr_b16 v[152:153], v7 offset:16384
    ds_read_b64_tr_b16 v[154:155], v7 offset:16896
    v_mfma_f32_16x16x32_bf16 v[52:55], v[84:87], v[120:123], v[52:55]
    ds_read_b128 v[88:91], v3 offset:0
    v_mfma_f32_16x16x32_bf16 v[52:55], v[76:79], v[124:127], v[52:55]
    ds_read_b64_tr_b16 v[156:157], v8 offset:16384
    ds_read_b64_tr_b16 v[158:159], v8 offset:16896
    v_mfma_f32_16x16x32_bf16 v[52:55], v[68:71], v[128:131], v[52:55]
    ds_read_b64_tr_b16 v[148:149], v8 offset:8192
    ds_read_b64_tr_b16 v[150:151], v8 offset:8704
    v_mfma_f32_16x16x32_bf16 v[60:63], v[68:71], v[132:135], v[60:63]
    ds_read_b64_tr_b16 v[140:141], v8 offset:0
    ds_read_b64_tr_b16 v[142:143], v8 offset:512
    v_mfma_f32_16x16x32_bf16 v[60:63], v[76:79], v[128:131], v[60:63]
    v_mfma_f32_16x16x32_bf16 v[60:63], v[84:87], v[124:127], v[60:63]
    ds_read_b128 v[100:103], v3 offset:768
    v_mfma_f32_16x16x32_bf16 v[56:59], v[80:83], v[124:127], v[56:59]
    v_mfma_f32_16x16x32_bf16 v[56:59], v[72:75], v[128:131], v[56:59]
    s_add_u32 s71, s71, 1
    s_cmp_lt_u32 s71, 5
    v_mfma_f32_16x16x32_bf16 v[56:59], v[64:67], v[132:135], v[56:59]
    s_cbranch_scc1 L_loop
    s_waitcnt lgkmcnt(13)
    v_mfma_f32_16x16x32_bf16 v[32:35], v[136:139], v[96:99], v[32:35]
    s_waitcnt lgkmcnt(10)
    v_mfma_f32_16x16x32_bf16 v[32:35], v[144:147], v[92:95], v[32:35]
    ds_read_b128 v[104:107], v5 offset:1024
    s_waitcnt lgkmcnt(8)
    v_mfma_f32_16x16x32_bf16 v[32:35], v[152:155], v[88:91], v[32:35]
    ds_read_b128 v[108:111], v5 offset:1280
    s_waitcnt lgkmcnt(7)
    v_mfma_f32_16x16x32_bf16 v[36:39], v[156:159], v[88:91], v[36:39]
    ds_read_b64_tr_b16 v[64:65], v7 offset:1024
    ds_read_b64_tr_b16 v[66:67], v7 offset:1536
    s_waitcnt lgkmcnt(7)
    v_mfma_f32_16x16x32_bf16 v[36:39], v[148:151], v[92:95], v[36:39]
    ds_read_b128 v[120:123], v4 offset:512
    s_waitcnt lgkmcnt(6)
    v_mfma_f32_16x16x32_bf16 v[36:39], v[140:143], v[96:99], v[36:39]
    s_waitcnt lgkmcnt(5)
    v_mfma_f32_16x16x32_bf16 v[44:47], v[140:143], v[100:103], v[44:47]
    ds_read_b64_tr_b16 v[72:73], v7 offset:9216
    ds_read_b64_tr_b16 v[74:75], v7 offset:9728
    v_mfma_f32_16x16x32_bf16 v[44:47], v[148:151], v[96:99], v[44:47]
    ds_read_b128 v[116:119], v4 offset:256
    v_mfma_f32_16x16x32_bf16 v[44:47], v[156:159], v[92:95], v[44:47]
    ds_read_b64_tr_b16 v[80:81], v7 offset:17408
    ds_read_b64_tr_b16 v[82:83], v7 offset:17920
    v_mfma_f32_16x16x32_bf16 v[40:43], v[152:155], v[92:95], v[40:43]
    ds_read_b128 v[112:115], v4 offset:0
    v_mfma_f32_16x16x32_bf16 v[40:43], v[144:147], v[96:99], v[40:43]
    v_mfma_f32_16x16x32_bf16 v[40:43], v[136:139], v[100:103], v[40:43]
    ds_read_b64_tr_b16 v[84:85], v8 offset:17408
    ds_read_b64_tr_b16 v[86:87], v8 offset:17920
    s_waitcnt lgkmcnt(9)
    v_mfma_f32_16x16x32_bf16 v[48:51], v[136:139], v[104:107], v[48:51]
    ds_read_b64_tr_b16 v[76:77], v8 offset:9216
    ds_read_b64_tr_b16 v[78:79], v8 offset:9728
    v_mfma_f32_16x16x32_bf16 v[48:51], v[144:147], v[100:103], v[48:51]
    ds_read_b64_tr_b16 v[68:69], v8 offset:1024
    ds_read_b64_tr_b16 v[70:71], v8 offset:1536
    v_mfma_f32_16x16x32_bf16 v[48:51], v[152:155], v[96:99], v[48:51]
    ds_read_b128 v[124:127], v4 offset:768
    v_mfma_f32_16x16x32_bf16 v[52:55], v[156:159], v[96:99], v[52:55]
    v_mfma_f32_16x16x32_bf16 v[52:55], v[148:151], v[100:103], v[52:55]
    ds_read_b128 v[128:131], v6 offset:1024
    v_mfma_f32_16x16x32_bf16 v[52:55], v[140:143], v[104:107], v[52:55]
    ds_read_b128 v[132:135], v6 offset:1280
    v_mfma_f32_16x16x32_bf16 v[60:63], v[140:143], v[108:111], v[60:63]
    v_mfma_f32_16x16x32_bf16 v[60:63], v[148:151], v[104:107], v[60:63]
    v_mfma_f32_16x16x32_bf16 v[60:63], v[156:159], v[100:103], v[60:63]
    s_add_u32 s7, s7, 1
    v_mfma_f32_16x16x32_bf16 v[56:59], v[152:155], v[100:103], v[56:59]
    v_lshrrev_b32 v14, v23, s7
    v_mfma_f32_16x16x32_bf16 v[56:59], v[144:147], v[104:107], v[56:59]
    v_add3_u32 v14, v14, s7, v25
    v_mfma_f32_16x16x32_bf16 v[56:59], v[136:139], v[108:111], v[56:59]
    v_and_b32 v14, 63, v14
    s_waitcnt lgkmcnt(2)
    v_mfma_f32_16x16x32_bf16 v[32:35], v[64:67], v[120:123], v[32:35]
    v_lshl_or_b32 v14, v14, 13, v14
    v_mfma_f32_16x16x32_bf16 v[32:35], v[72:75], v[116:119], v[32:35]
    v_and_b32 v14, s64, v14
    v_mfma_f32_16x16x32_bf16 v[32:35], v[80:83], v[112:115], v[32:35]
    v_xor_b32 v25, s54, v14
    v_mfma_f32_16x16x32_bf16 v[36:39], v[84:87], v[112:115], v[36:39]
    ds_read_b32 v24, v15 offset:0
    v_mov_b32 v14, s7
    v_mfma_f32_16x16x32_bf16 v[36:39], v[76:79], v[116:119], v[36:39]
    v_mfma_f32_16x16x32_bf16 v[36:39], v[68:71], v[120:123], v[36:39]
    v_mfma_f32_16x16x32_bf16 v[44:47], v[68:71], v[124:127], v[44:47]
    v_add_u32 v3, 4294883328, v3
    v_add_u32 v5, 4294883328, v5
    v_mfma_f32_16x16x32_bf16 v[44:47], v[76:79], v[120:123], v[44:47]
    v_add_u32 v7, 4294883328, v7
    v_add_u32 v8, 4294883328, v8
    v_mfma_f32_16x16x32_bf16 v[44:47], v[84:87], v[116:119], v[44:47]
    v_add_u32 v4, 4294883328, v4
    v_add_u32 v6, 4294883328, v6
    s_waitcnt lgkmcnt(0)
    v_cmp_ne_u32 vcc, 0, v24
    v_mfma_f32_16x16x32_bf16 v[40:43], v[80:83], v[116:119], v[40:43]
    s_cbranch_vccnz L_fspin6
L_fok6:
    ds_read_b64_tr_b16 v[136:137], v7 offset:0
    ds_read_b64_tr_b16 v[138:139], v7 offset:512
    v_mfma_f32_16x16x32_bf16 v[40:43], v[72:75], v[120:123], v[40:43]
    ds_read_b128 v[192:195], v3 offset:512
    v_mfma_f32_16x16x32_bf16 v[40:43], v[64:67], v[124:127], v[40:43]
    ds_read_b64_tr_b16 v[144:145], v7 offset:8192
    ds_read_b64_tr_b16 v[146:147], v7 offset:8704
    v_mfma_f32_16x16x32_bf16 v[48:51], v[64:67], v[128:131], v[48:51]
    ds_read_b128 v[188:191], v3 offset:256
    v_mfma_f32_16x16x32_bf16 v[48:51], v[72:75], v[124:127], v[48:51]
    ds_read_b64_tr_b16 v[152:153], v7 offset:16384
    ds_read_b64_tr_b16 v[154:155], v7 offset:16896
    v_mfma_f32_16x16x32_bf16 v[48:51], v[80:83], v[120:123], v[48:51]
    v_mfma_f32_16x16x32_bf16 v[52:55], v[84:87], v[120:123], v[52:55]
    ds_read_b128 v[184:187], v3 offset:0
    v_mfma_f32_16x16x32_bf16 v[52:55], v[76:79], v[124:127], v[52:55]
    ds_read_b64_tr_b16 v[156:157], v8 offset:16384
    ds_read_b64_tr_b16 v[158:159], v8 offset:16896
    v_mfma_f32_16x16x32_bf16 v[52:55], v[68:71], v[128:131], v[52:55]
    ds_read_b64_tr_b16 v[148:149], v8 offset:8192
    ds_read_b64_tr_b16 v[150:151], v8 offset:8704
    v_mfma_f32_16x16x32_bf16 v[60:63], v[68:71], v[132:135], v[60:63]
    ds_read_b64_tr_b16 v[140:141], v8 offset:0
    ds_read_b64_tr_b16 v[142:143], v8 offset:512
    v_mfma_f32_16x16x32_bf16 v[60:63], v[76:79], v[128:131], v[60:63]
    v_mfma_f32_16x16x32_bf16 v[60:63], v[84:87], v[124:127], v[60:63]
    ds_read_b128 v[196:199], v3 offset:768
    v_mfma_f32_16x16x32_bf16 v[56:59], v[80:83], v[124:127], v[56:59]
    ds_read_b128 v[200:203], v5 offset:1024
    v_mfma_f32_16x16x32_bf16 v[56:59], v[72:75], v[128:131], v[56:59]
    ds_read_b64_tr_b16 v[160:161], v7 offset:1024
    ds_read_b64_tr_b16 v[162:163], v7 offset:1536
    v_mfma_f32_16x16x32_bf16 v[56:59], v[64:67], v[132:135], v[56:59]
    ds_read_b128 v[216:219], v4 offset:512
    s_waitcnt lgkmcnt(11)
    v_mfma_f32_16x16x32_bf16 v[32:35], v[136:139], v[192:195], v[32:35]
    v_mfma_f32_16x16x32_bf16 v[32:35], v[144:147], v[188:191], v[32:35]
    ds_read_b64_tr_b16 v[168:169], v7 offset:9216
    ds_read_b64_tr_b16 v[170:171], v7 offset:9728
    v_mfma_f32_16x16x32_bf16 v[32:35], v[152:155], v[184:187], v[32:35]
    ds_read_b128 v[212:215], v4 offset:256
    s_waitcnt lgkmcnt(8)
    v_mfma_f32_16x16x32_bf16 v[36:39], v[156:159], v[184:187], v[36:39]
    ds_read_b64_tr_b16 v[176:177], v7 offset:17408
    ds_read_b64_tr_b16 v[178:179], v7 offset:17920
    v_mfma_f32_16x16x32_bf16 v[36:39], v[148:151], v[188:191], v[36:39]
    ds_read_b128 v[208:211], v4 offset:0
    v_mfma_f32_16x16x32_bf16 v[36:39], v[140:143], v[192:195], v[36:39]
    s_waitcnt lgkmcnt(9)
    v_mfma_f32_16x16x32_bf16 v[44:47], v[140:143], v[196:199], v[44:47]
    ds_read_b64_tr_b16 v[180:181], v8 offset:17408
    ds_read_b64_tr_b16 v[182:183], v8 offset:17920
    v_mfma_f32_16x16x32_bf16 v[44:47], v[148:151], v[192:195], v[44:47]
    ds_read_b64_tr_b16 v[172:173], v8 offset:9216
    ds_read_b64_tr_b16 v[174:175], v8 offset:9728
    v_mfma_f32_16x16x32_bf16 v[44:47], v[156:159], v[188:191], v[44:47]
    ds_read_b64_tr_b16 v[164:165], v8 offset:1024
    ds_read_b64_tr_b16 v[166:167], v8 offset:1536
    v_mfma_f32_16x16x32_bf16 v[40:43], v[152:155], v[188:191], v[40:43]
    ds_read_b128 v[220:223], v4 offset:768
    v_mfma_f32_16x16x32_bf16 v[40:43], v[144:147], v[192:195], v[40:43]
    v_mfma_f32_16x16x32_bf16 v[40:43], v[136:139], v[196:199], v[40:43]
    ds_read_b128 v[224:227], v6 offset:1024
    v_mfma_f32_16x16x32_bf16 v[48:51], v[136:139], v[200:203], v[48:51]
    v_mfma_f32_16x16x32_bf16 v[48:51], v[144:147], v[196:199], v[48:51]
    v_mfma_f32_16x16x32_bf16 v[48:51], v[152:155], v[192:195], v[48:51]
    v_mfma_f32_16x16x32_bf16 v[52:55], v[156:159], v[192:195], v[52:55]
    v_mfma_f32_16x16x32_bf16 v[52:55], v[148:151], v[196:199], v[52:55]
    v_mfma_f32_16x16x32_bf16 v[52:55], v[140:143], v[200:203], v[52:55]
    s_waitcnt lgkmcnt(1)
    v_mfma_f32_16x16x32_bf16 v[32:35], v[160:163], v[216:219], v[32:35]
    ds_read_b32 v24, v15 offset:16
    v_mfma_f32_16x16x32_bf16 v[32:35], v[168:171], v[212:215], v[32:35]
    v_mfma_f32_16x16x32_bf16 v[32:35], v[176:179], v[208:211], v[32:35]
    v_mfma_f32_16x16x32_bf16 v[36:39], v[180:183], v[208:211], v[36:39]
    v_mfma_f32_16x16x32_bf16 v[36:39], v[172:175], v[212:215], v[36:39]
    v_mfma_f32_16x16x32_bf16 v[36:39], v[164:167], v[216:219], v[36:39]
    s_waitcnt lgkmcnt(0)
    v_cmp_ne_u32 vcc, 0, v24
    v_mfma_f32_16x16x32_bf16 v[44:47], v[164:167], v[220:223], v[44:47]
    s_cbranch_vccnz L_fspin7
L_fok7:
    ds_read_b64_tr_b16 v[80:81], v7 offset:58368
    ds_read_b64_tr_b16 v[82:83], v7 offset:58880
    ds_read_b128 v[112:115], v3 offset:41984
    v_mfma_f32_16x16x32_bf16 v[44:47], v[172:175], v[216:219], v[44:47]
    ds_read_b64_tr_b16 v[72:73], v7 offset:50176
    ds_read_b64_tr_b16 v[74:75], v7 offset:50688
    v_mfma_f32_16x16x32_bf16 v[44:47], v[180:183], v[212:215], v[44:47]
    ds_read_b128 v[116:119], v3 offset:42240
    v_mfma_f32_16x16x32_bf16 v[40:43], v[176:179], v[212:215], v[40:43]
    ds_read_b64_tr_b16 v[64:65], v7 offset:41984
    ds_read_b64_tr_b16 v[66:67], v7 offset:42496
    ds_read_b128 v[120:123], v3 offset:42496
    v_mfma_f32_16x16x32_bf16 v[40:43], v[168:171], v[216:219], v[40:43]
    ds_read_b64_tr_b16 v[104:105], v7 offset:59392
    ds_read_b64_tr_b16 v[106:107], v7 offset:59904
    v_mfma_f32_16x16x32_bf16 v[40:43], v[160:163], v[220:223], v[40:43]
    ds_read_b128 v[124:127], v4 offset:41984
    v_mfma_f32_16x16x32_bf16 v[48:51], v[160:163], v[224:227], v[48:51]
    ds_read_b64_tr_b16 v[96:97], v7 offset:51200
    ds_read_b64_tr_b16 v[98:99], v7 offset:51712
    ds_read_b128 v[128:131], v4 offset:42240
    v_mfma_f32_16x16x32_bf16 v[48:51], v[168:171], v[220:223], v[48:51]
    ds_read_b64_tr_b16 v[88:89], v7 offset:43008
    ds_read_b64_tr_b16 v[90:91], v7 offset:43520
    v_mfma_f32_16x16x32_bf16 v[48:51], v[176:179], v[216:219], v[48:51]
    ds_read_b128 v[132:135], v4 offset:42496
    v_mfma_f32_16x16x32_bf16 v[52:55], v[180:183], v[216:219], v[52:55]
    ds_read_b64_tr_b16 v[84:85], v8 offset:58368
    ds_read_b64_tr_b16 v[86:87], v8 offset:58880
    ds_read_b64_tr_b16 v[76:77], v8 offset:50176
    ds_read_b64_tr_b16 v[78:79], v8 offset:50688
    v_mfma_f32_16x16x32_bf16 v[52:55], v[172:175], v[220:223], v[52:55]
    ds_read_b64_tr_b16 v[68:69], v8 offset:41984
    ds_read_b64_tr_b16 v[70:71], v8 offset:42496
    v_mfma_f32_16x16x32_bf16 v[52:55], v[164:167], v[224:227], v[52:55]
    ds_read_b64_tr_b16 v[108:109], v8 offset:59392
    ds_read_b64_tr_b16 v[110:111], v8 offset:59904
    s_waitcnt lgkmcnt(15)
    v_mfma_f32_16x16x32_bf16 v[32:35], v[80:83], v[112:115], v[32:35]
    ds_read_b64_tr_b16 v[100:101], v8 offset:51200
    ds_read_b64_tr_b16 v[102:103], v8 offset:51712
    v_mfma_f32_16x16x32_bf16 v[32:35], v[72:75], v[116:119], v[32:35]
    ds_read_b64_tr_b16 v[92:93], v8 offset:43008
    ds_read_b64_tr_b16 v[94:95], v8 offset:43520
    ds_read_b128 v[204:207], v5 offset:1280
    v_mfma_f32_16x16x32_bf16 v[32:35], v[64:67], v[120:123], v[32:35]
    ds_read_b128 v[228:231], v6 offset:1280
    s_waitcnt lgkmcnt(15)
    v_mfma_f32_16x16x32_bf16 v[32:35], v[104:107], v[124:127], v[32:35]
    v_mfma_f32_16x16x32_bf16 v[32:35], v[96:99], v[128:131], v[32:35]
    s_waitcnt lgkmcnt(14)
    v_mfma_f32_16x16x32_bf16 v[32:35], v[88:91], v[132:135], v[32:35]
    s_waitcnt lgkmcnt(10)
    v_mfma_f32_16x16x32_bf16 v[36:39], v[84:87], v[112:115], v[36:39]
    ds_read_b128 v[112:115], v3 offset:42752
    v_mfma_f32_16x16x32_bf16 v[36:39], v[76:79], v[116:119], v[36:39]
    v_mul_f32 v232, s4, v32
    v_mul_f32 v233, s4, v33
    s_waitcnt lgkmcnt(7)
    v_mfma_f32_16x16x32_bf16 v[36:39], v[68:71], v[120:123], v[36:39]
    v_mul_f32 v234, s4, v34
    v_mul_f32 v235, s4, v35
    v_mfma_f32_16x16x32_bf16 v[36:39], v[108:111], v[124:127], v[36:39]
    ds_read_b128 v[124:127], v4 offset:42752
    v_exp_f32 v232, v232
    s_waitcnt lgkmcnt(3)
    v_mfma_f32_16x16x32_bf16 v[36:39], v[100:103], v[128:131], v[36:39]
    v_exp_f32 v233, v233
    v_mfma_f32_16x16x32_bf16 v[36:39], v[92:95], v[132:135], v[36:39]
    v_exp_f32 v234, v234
    v_mfma_f32_16x16x32_bf16 v[40:43], v[80:83], v[116:119], v[40:43]
    v_exp_f32 v235, v235
    v_mfma_f32_16x16x32_bf16 v[40:43], v[72:75], v[120:123], v[40:43]
    v_add_f32 v232, 1.0, v232
    v_add_f32 v233, 1.0, v233
    s_waitcnt lgkmcnt(1)
    v_mfma_f32_16x16x32_bf16 v[40:43], v[64:67], v[112:115], v[40:43]
    v_mul_f32 v236, s4, v36
    v_mul_f32 v237, s4, v37
    v_mul_f32 v238, s4, v38
    v_mul_f32 v239, s4, v39
    v_mfma_f32_16x16x32_bf16 v[40:43], v[104:107], v[128:131], v[40:43]
    v_exp_f32 v236, v236
    v_exp_f32 v237, v237
    v_mfma_f32_16x16x32_bf16 v[40:43], v[96:99], v[132:135], v[40:43]
    v_exp_f32 v238, v238
    v_exp_f32 v239, v239
    s_waitcnt lgkmcnt(0)
    v_mfma_f32_16x16x32_bf16 v[40:43], v[88:91], v[124:127], v[40:43]
    v_add_f32 v234, 1.0, v234
    v_add_f32 v235, 1.0, v235
    v_add_f32 v236, 1.0, v236
    v_add_f32 v237, 1.0, v237
    v_mfma_f32_16x16x32_bf16 v[44:47], v[84:87], v[116:119], v[44:47]
    ds_read_b128 v[116:119], v5 offset:43008
    v_add_f32 v238, 1.0, v238
    v_add_f32 v239, 1.0, v239
    v_rcp_f32 v232, v232
    v_mfma_f32_16x16x32_bf16 v[44:47], v[76:79], v[120:123], v[44:47]
    v_rcp_f32 v233, v233
    v_rcp_f32 v234, v234
    v_mfma_f32_16x16x32_bf16 v[44:47], v[68:71], v[112:115], v[44:47]
    v_rcp_f32 v235, v235
    v_rcp_f32 v236, v236
    v_mfma_f32_16x16x32_bf16 v[44:47], v[108:111], v[128:131], v[44:47]
    ds_read_b128 v[128:131], v6 offset:43008
    v_rcp_f32 v237, v237
    v_rcp_f32 v238, v238
    v_mfma_f32_16x16x32_bf16 v[44:47], v[100:103], v[132:135], v[44:47]
    v_rcp_f32 v239, v239
    v_fma_f32 v232, v232, v30, v31
    v_fma_f32 v233, v233, v30, v31
    v_mfma_f32_16x16x32_bf16 v[44:47], v[92:95], v[124:127], v[44:47]
    v_fma_f32 v234, v234, v30, v31
    v_fma_f32 v235, v235, v30, v31
    v_fma_f32 v236, v236, v30, v31
    v_fma_f32 v237, v237, v30, v31
    v_mfma_f32_16x16x32_bf16 v[48:51], v[80:83], v[120:123], v[48:51]
    v_fma_f32 v238, v238, v30, v31
    v_fma_f32 v239, v239, v30, v31
    v_cvt_pk_f16_f32 v240, v232, v233
    v_cvt_pk_f16_f32 v241, v234, v235
    v_mfma_f32_16x16x32_bf16 v[48:51], v[72:75], v[112:115], v[48:51]
    v_bfi_b32 v240, s64, v25, v240
    v_cvt_pk_f16_f32 v242, v236, v237
    v_cvt_pk_f16_f32 v243, v238, v239
    buffer_store_dwordx4 v[240:243], v9, s[36:39], 0 offen sc1
    s_waitcnt lgkmcnt(1)
    v_mfma_f32_16x16x32_bf16 v[48:51], v[64:67], v[116:119], v[48:51]
    v_mul_f32 v232, s4, v40
    v_mul_f32 v233, s4, v41
    v_mul_f32 v234, s4, v42
    v_mul_f32 v235, s4, v43
    v_mul_f32 v236, s4, v44
    v_mfma_f32_16x16x32_bf16 v[48:51], v[104:107], v[132:135], v[48:51]
    v_mul_f32 v237, s4, v45
    v_mul_f32 v238, s4, v46
    v_mul_f32 v239, s4, v47
    v_exp_f32 v232, v232
    v_mfma_f32_16x16x32_bf16 v[48:51], v[96:99], v[124:127], v[48:51]
    v_exp_f32 v233, v233
    v_exp_f32 v234, v234
    s_waitcnt lgkmcnt(0)
    v_mfma_f32_16x16x32_bf16 v[48:51], v[88:91], v[128:131], v[48:51]
    v_exp_f32 v235, v235
    v_exp_f32 v236, v236
    v_mfma_f32_16x16x32_bf16 v[52:55], v[84:87], v[120:123], v[52:55]
    ds_read_b128 v[120:123], v5 offset:43264
    v_exp_f32 v237, v237
    v_exp_f32 v238, v238
    v_mfma_f32_16x16x32_bf16 v[52:55], v[76:79], v[112:115], v[52:55]
    v_exp_f32 v239, v239
    v_add_f32 v232, 1.0, v232
    v_add_f32 v233, 1.0, v233
    v_add_f32 v234, 1.0, v234
    v_mfma_f32_16x16x32_bf16 v[52:55], v[68:71], v[116:119], v[52:55]
    v_add_f32 v235, 1.0, v235
    v_add_f32 v236, 1.0, v236
    v_add_f32 v237, 1.0, v237
    v_add_f32 v238, 1.0, v238
    v_add_f32 v239, 1.0, v239
    v_mfma_f32_16x16x32_bf16 v[52:55], v[108:111], v[132:135], v[52:55]
    ds_read_b128 v[132:135], v6 offset:43264
    v_rcp_f32 v232, v232
    v_rcp_f32 v233, v233
    v_mfma_f32_16x16x32_bf16 v[52:55], v[100:103], v[124:127], v[52:55]
    v_rcp_f32 v234, v234
    v_rcp_f32 v235, v235
    v_mfma_f32_16x16x32_bf16 v[52:55], v[92:95], v[128:131], v[52:55]
    v_rcp_f32 v236, v236
    v_rcp_f32 v237, v237
    v_mfma_f32_16x16x32_bf16 v[56:59], v[152:155], v[196:199], v[56:59]
    v_rcp_f32 v238, v238
    v_rcp_f32 v239, v239
    v_fma_f32 v232, v232, v30, v31
    v_mfma_f32_16x16x32_bf16 v[56:59], v[144:147], v[200:203], v[56:59]
    v_fma_f32 v233, v233, v30, v31
    v_fma_f32 v234, v234, v30, v31
    v_fma_f32 v235, v235, v30, v31
    v_fma_f32 v236, v236, v30, v31
    v_fma_f32 v237, v237, v30, v31
    v_fma_f32 v238, v238, v30, v31
    v_fma_f32 v239, v239, v30, v31
    v_cvt_pk_f16_f32 v244, v232, v233
    v_cvt_pk_f16_f32 v245, v234, v235
    v_bfi_b32 v244, s64, v25, v244
    v_cvt_pk_f16_f32 v246, v236, v237
    v_cvt_pk_f16_f32 v247, v238, v239
    buffer_store_dwordx4 v[244:247], v9, s[36:39], s33 offen sc1
    v_mfma_f32_16x16x32_bf16 v[56:59], v[136:139], v[204:207], v[56:59]
    v_mul_f32 v232, s4, v48
    v_mul_f32 v233, s4, v49
    v_mul_f32 v234, s4, v50
    v_mfma_f32_16x16x32_bf16 v[56:59], v[176:179], v[220:223], v[56:59]
    v_mul_f32 v235, s4, v51
    v_mul_f32 v236, s4, v52
    v_mul_f32 v237, s4, v53
    v_mfma_f32_16x16x32_bf16 v[56:59], v[168:171], v[224:227], v[56:59]
    v_mul_f32 v238, s4, v54
    v_mul_f32 v239, s4, v55
    v_mfma_f32_16x16x32_bf16 v[56:59], v[160:163], v[228:231], v[56:59]
    v_exp_f32 v232, v232
    v_mfma_f32_16x16x32_bf16 v[60:63], v[156:159], v[196:199], v[60:63]
    v_exp_f32 v233, v233
    v_mfma_f32_16x16x32_bf16 v[60:63], v[148:151], v[200:203], v[60:63]
    v_exp_f32 v234, v234
    v_mfma_f32_16x16x32_bf16 v[60:63], v[140:143], v[204:207], v[60:63]
    v_exp_f32 v235, v235
    v_mfma_f32_16x16x32_bf16 v[60:63], v[180:183], v[220:223], v[60:63]
    v_exp_f32 v236, v236
    v_mfma_f32_16x16x32_bf16 v[60:63], v[172:175], v[224:227], v[60:63]
    v_exp_f32 v237, v237
    v_mfma_f32_16x16x32_bf16 v[60:63], v[164:167], v[228:231], v[60:63]
    v_exp_f32 v238, v238
    v_mfma_f32_16x16x32_bf16 v[56:59], v[80:83], v[112:115], v[56:59]
    v_exp_f32 v239, v239
    v_add_f32 v232, 1.0, v232
    v_mfma_f32_16x16x32_bf16 v[56:59], v[72:75], v[116:119], v[56:59]
    v_add_f32 v233, 1.0, v233
    v_add_f32 v234, 1.0, v234
    v_add_f32 v235, 1.0, v235
    s_waitcnt lgkmcnt(0)
    v_mfma_f32_16x16x32_bf16 v[56:59], v[64:67], v[120:123], v[56:59]
    v_add_f32 v236, 1.0, v236
    v_add_f32 v237, 1.0, v237
    v_add_f32 v238, 1.0, v238
    v_mfma_f32_16x16x32_bf16 v[56:59], v[104:107], v[124:127], v[56:59]
    v_add_f32 v239, 1.0, v239
    v_rcp_f32 v232, v232
    v_mfma_f32_16x16x32_bf16 v[56:59], v[96:99], v[128:131], v[56:59]
    v_rcp_f32 v233, v233
    v_mfma_f32_16x16x32_bf16 v[56:59], v[88:91], v[132:135], v[56:59]
    v_rcp_f32 v234, v234
    v_mfma_f32_16x16x32_bf16 v[60:63], v[84:87], v[112:115], v[60:63]
    v_rcp_f32 v235, v235
    v_mfma_f32_16x16x32_bf16 v[60:63], v[76:79], v[116:119], v[60:63]
    v_rcp_f32 v236, v236
    v_mfma_f32_16x16x32_bf16 v[60:63], v[68:71], v[120:123], v[60:63]
    v_rcp_f32 v237, v237
    v_mfma_f32_16x16x32_bf16 v[60:63], v[108:111], v[124:127], v[60:63]
    v_rcp_f32 v238, v238
    v_mfma_f32_16x16x32_bf16 v[60:63], v[100:103], v[128:131], v[60:63]
    v_rcp_f32 v239, v239
    v_fma_f32 v232, v232, v30, v31
    v_mfma_f32_16x16x32_bf16 v[60:63], v[92:95], v[132:135], v[60:63]
    v_fma_f32 v233, v233, v30, v31
    v_fma_f32 v234, v234, v30, v31
    v_fma_f32 v235, v235, v30, v31
    v_fma_f32 v236, v236, v30, v31
    v_fma_f32 v237, v237, v30, v31
    v_fma_f32 v238, v238, v30, v31
    v_fma_f32 v239, v239, v30, v31
    v_cvt_pk_f16_f32 v240, v232, v233
    v_cvt_pk_f16_f32 v241, v234, v235
    v_bfi_b32 v240, s64, v25, v240
    v_cvt_pk_f16_f32 v242, v236, v237
    v_cvt_pk_f16_f32 v243, v238, v239
    buffer_store_dwordx4 v[240:243], v9, s[36:39], s34 offen sc1
    v_pk_mul_f32 v[232:233], v[56:57], s[4:5] op_sel_hi:[1,0]
    v_pk_mul_f32 v[234:235], v[58:59], s[4:5] op_sel_hi:[1,0]
    v_pk_mul_f32 v[236:237], v[60:61], s[4:5] op_sel_hi:[1,0]
    v_pk_mul_f32 v[238:239], v[62:63], s[4:5] op_sel_hi:[1,0]
    v_exp_f32 v232, v232
    v_exp_f32 v233, v233
    v_exp_f32 v234, v234
    v_exp_f32 v235, v235
    v_exp_f32 v236, v236
    v_exp_f32 v237, v237
    v_exp_f32 v238, v238
    v_exp_f32 v239, v239
    v_pk_add_f32 v[232:233], v[232:233], 1.0 op_sel_hi:[1,0]
    v_pk_add_f32 v[234:235], v[234:235], 1.0 op_sel_hi:[1,0]
    v_pk_add_f32 v[236:237], v[236:237], 1.0 op_sel_hi:[1,0]
    v_pk_add_f32 v[238:239], v[238:239], 1.0 op_sel_hi:[1,0]
    v_rcp_f32 v232, v232
    v_rcp_f32 v233, v233
    v_rcp_f32 v234, v234
    v_rcp_f32 v235, v235
    v_rcp_f32 v236, v236
    v_rcp_f32 v237, v237
    v_rcp_f32 v238, v238
    v_rcp_f32 v239, v239
    v_pk_fma_f32 v[232:233], v[232:233], v[30:31], v[30:31] op_sel:[0,0,1] op_sel_hi:[1,0,1]
    v_pk_fma_f32 v[234:235], v[234:235], v[30:31], v[30:31] op_sel:[0,0,1] op_sel_hi:[1,0,1]
    v_pk_fma_f32 v[236:237], v[236:237], v[30:31], v[30:31] op_sel:[0,0,1] op_sel_hi:[1,0,1]
    v_pk_fma_f32 v[238:239], v[238:239], v[30:31], v[30:31] op_sel:[0,0,1] op_sel_hi:[1,0,1]
    v_cvt_pk_f16_f32 v244, v232, v233
    v_cvt_pk_f16_f32 v245, v234, v235
    v_bfi_b32 v244, s64, v25, v244
    v_cvt_pk_f16_f32 v246, v236, v237
    v_cvt_pk_f16_f32 v247, v238, v239
    buffer_store_dwordx4 v[244:247], v9, s[36:39], s35 offen sc1
    s_setprio 0
    s_mov_b32 s71, 0
L_pp:
    s_barrier
    s_waitcnt vmcnt(0)
    s_barrier
    s_barrier
    s_barrier
    s_barrier
    s_barrier
    ds_read_b128 v[64:67], v28 offset:0
    ds_read_b128 v[68:71], v28 offset:1024
    ds_read_b128 v[72:75], v28 offset:8192
    ds_read_b128 v[76:79], v28 offset:9216
    ds_read_b128 v[80:83], v28 offset:16384
    ds_read_b128 v[84:87], v28 offset:17408
    ds_read_b128 v[88:91], v28 offset:24576
    ds_read_b128 v[92:95], v28 offset:25600
    s_or_b32 s44, s41, s42
    s_cbranch_scc1 L_noep
    v_and_b32 v20, 31, v1
    v_lshlrev_b32 v20, 2, v20
    buffer_store_dword v14, v20, s[36:39], s32 offen sc1
L_noep:
    s_waitcnt lgkmcnt(4)
    v_add_f32 v64, v64, v72
    v_add_f32 v65, v65, v73
    v_add_f32 v66, v66, v74
    v_add_f32 v67, v67, v75
    v_add_f32 v68, v68, v76
    v_add_f32 v69, v69, v77
    v_add_f32 v70, v70, v78
    v_add_f32 v71, v71, v79
    s_waitcnt lgkmcnt(2)
    v_add_f32 v64, v64, v80
    v_add_f32 v65, v65, v81
    v_add_f32 v66, v66, v82
    v_add_f32 v67, v67, v83
    v_add_f32 v68, v68, v84
    v_add_f32 v69, v69, v85
    v_add_f32 v70, v70, v86
    v_add_f32 v71, v71, v87
    s_waitcnt lgkmcnt(0)
    v_add_f32 v64, v64, v88
    v_add_f32 v65, v65, v89
    v_add_f32 v66, v66, v90
    v_add_f32 v67, v67, v91
    v_add_f32 v68, v68, v92
    v_add_f32 v69, v69, v93
    v_add_f32 v70, v70, v94
    v_add_f32 v71, v71, v95
    v_mul_f32 v64, s6, v64
    v_mul_f32 v65, s6, v65
    v_mul_f32 v66, s6, v66
    v_mul_f32 v67, s6, v67
    v_mul_f32 v68, s6, v68
    v_mul_f32 v69, s6, v69
    v_mul_f32 v70, s6, v70
    v_mul_f32 v71, s6, v71
    v_cvt_pk_bf16_f32 v96, v64, v68
    v_cvt_pk_bf16_f32 v98, v66, v70
    v_cvt_pk_bf16_f32 v97, v65, v69
    v_cvt_pk_bf16_f32 v99, v67, v71
    v_permlane32_swap_b32 v96, v98
    s_nop 0
    v_permlane32_swap_b32 v97, v99
    s_nop 1
    v_permlane16_swap_b32 v96, v97
    v_permlane16_swap_b32 v98, v99
    buffer_store_dwordx4 v[96:99], v29, s[28:31], 0 offen sc1
    s_barrier
    ds_read_b128 v[64:67], v28 offset:32768
    ds_read_b128 v[68:71], v28 offset:33792
    ds_read_b128 v[72:75], v28 offset:40960
    ds_read_b128 v[76:79], v28 offset:41984
    ds_read_b128 v[80:83], v28 offset:49152
    ds_read_b128 v[84:87], v28 offset:50176
    ds_read_b128 v[88:91], v28 offset:57344
    ds_read_b128 v[92:95], v28 offset:58368
    s_waitcnt lgkmcnt(4)
    v_pk_add_f32 v[64:65], v[64:65], v[72:73]
    v_pk_add_f32 v[66:67], v[66:67], v[74:75]
    v_pk_add_f32 v[68:69], v[68:69], v[76:77]
    v_pk_add_f32 v[70:71], v[70:71], v[78:79]
    s_waitcnt lgkmcnt(2)
    v_pk_add_f32 v[64:65], v[64:65], v[80:81]
    v_pk_add_f32 v[66:67], v[66:67], v[82:83]
    v_pk_add_f32 v[68:69], v[68:69], v[84:85]
    v_pk_add_f32 v[70:71], v[70:71], v[86:87]
    s_waitcnt lgkmcnt(0)
    v_pk_add_f32 v[64:65], v[64:65], v[88:89]
    v_pk_add_f32 v[66:67], v[66:67], v[90:91]
    v_pk_add_f32 v[68:69], v[68:69], v[92:93]
    v_pk_add_f32 v[70:71], v[70:71], v[94:95]
    v_pk_mul_f32 v[64:65], v[64:65], s[6:7] op_sel_hi:[1,0]
    v_pk_mul_f32 v[68:69], v[68:69], s[6:7] op_sel_hi:[1,0]
    v_pk_mul_f32 v[66:67], v[66:67], s[6:7] op_sel_hi:[1,0]
    v_pk_mul_f32 v[70:71], v[70:71], s[6:7] op_sel_hi:[1,0]
    v_cvt_pk_bf16_f32 v100, v64, v68
    v_cvt_pk_bf16_f32 v102, v66, v70
    v_cvt_pk_bf16_f32 v101, v65, v69
    v_cvt_pk_bf16_f32 v103, v67, v71
    v_permlane32_swap_b32 v100, v102
    s_nop 0
    v_permlane32_swap_b32 v101, v103
    s_nop 1
    v_permlane16_swap_b32 v100, v101
    v_permlane16_swap_b32 v102, v103
    buffer_store_dwordx4 v[100:103], v29, s[28:31], s33 offen sc1
    s_endpgm
L_fspin6:
    s_add_u32 s62, s62, 1
    s_cmp_ge_u32 s62, 0x100000
    s_cbranch_scc1 L_end
    ds_read_b32 v24, v15 offset:0
    s_waitcnt lgkmcnt(0)
    v_cmp_ne_u32 vcc, 0, v24
    s_cbranch_vccnz L_fspin6
    s_branch L_fok6
L_fspin7:
    s_add_u32 s62, s62, 1
    s_cmp_ge_u32 s62, 0x100000
    s_cbranch_scc1 L_end
    ds_read_b32 v24, v15 offset:16
    s_waitcnt lgkmcnt(0)
    v_cmp_ne_u32 vcc, 0, v24
    s_cbranch_vccnz L_fspin7
    s_branch L_fok7
L_end:
    s_endpgm
.section .rodata,"a"
.p2align 6
.amdhsa_kernel standalone__autoregressive_conv_wavenet__speech_kernel
  .amdhsa_next_free_vgpr 256
  .amdhsa_next_free_sgpr 102
  .amdhsa_accum_offset 256
  .amdhsa_group_segment_fixed_size 0
  .amdhsa_kernarg_size 48
  .amdhsa_user_sgpr_count 2
  .amdhsa_user_sgpr_kernarg_segment_ptr 1
  .amdhsa_system_sgpr_workgroup_id_x 1
.end_amdhsa_kernel
```
